```python
import torch

def _softmax(x, axis=-1):
    return torch.softmax(x, dim=axis)
def _gelu(x):
    return torch.nn.functional.gelu(x, approximate="tanh")
def _silu(x):
    return torch.nn.functional.silu(x)
def _sigmoid(x):
    return torch.sigmoid(x)
def _layernorm(x, axis=-1, eps=1e-5):
    m = x.mean(dim=axis, keepdim=True)
    v = x.var(dim=axis, keepdim=True, unbiased=False)
    return (x - m) / torch.sqrt(v + eps)
def _scatter_add(tgt, idx, src, axis=0):
    return tgt.clone().index_add_(axis, idx, src)
def _segment_sum(src, seg, n):
    out = torch.zeros((n,) + src.shape[1:], dtype=src.dtype)
    return out.index_add_(0, seg, src)
def _pad(x, pw):
    flat = tuple(v for pair in reversed(pw) for v in pair)
    return torch.nn.functional.pad(x, flat)

kernel_name = 'gated_mix__sliding_block_cached__dense_activation_gelu__decode'

def setup_inputs():

    _w = (lambda a: (lambda t: t.to(torch.bfloat16) if t.is_floating_point() else t)(torch.as_tensor(a)))
    def _A_setup():
        B, Sq, D = 2, 1, 512
        Hq, Hkv, Sk, Dh = 32, 8, 8192, 128
        assert Hq % Hkv == 0, (Hq, Hkv)
        return {
            "x": _w((lambda *s: torch.randn(*s, dtype=torch.bfloat16) * 0.05)(B, Sq, D)),
            "k_cache": _w((lambda *s: torch.randn(*s, dtype=torch.bfloat16) * 6.4)(B, Hkv, Sk, Dh)),
            "v_cache": _w((lambda *s: torch.randn(*s, dtype=torch.bfloat16) * 0.4)(B, Hkv, Sk, Dh)),
            "wq": _w((lambda *s: torch.randn(*s, dtype=torch.bfloat16) * 6.4)(D, Hq * Dh) * (D ** -0.5)),
            "wo": _w((lambda *s: torch.randn(*s, dtype=torch.bfloat16) * 0.4)(Hq * Dh, D) * ((Hq * Dh) ** -0.5)),
        }
    _A_in = _A_setup()

    def _B_setup():
        B, S, D, F = 2, 1, 512, 1792
        return {
            "x": _w((lambda *s: torch.randn(*s, dtype=torch.bfloat16) * 0.05)(B, S, D)),
            "w1": _w((lambda *s: torch.randn(*s, dtype=torch.bfloat16) * 3.2)(D, F) * (D ** -0.5)),
            "b1": _w((lambda *s: torch.randn(*s, dtype=torch.bfloat16) * 3.2)(F) * 0.01),
            "w2": _w((lambda *s: torch.randn(*s, dtype=torch.bfloat16) * 0.4)(F, D) * (F ** -0.5)),
            "b2": _w((lambda *s: torch.randn(*s, dtype=torch.bfloat16) * 0.8)(D) * 0.01),
        }
    _B_in = _B_setup()

    return {
        "A_x": _A_in["x"],
        "A_k_cache": _A_in["k_cache"],
        "A_v_cache": _A_in["v_cache"],
        "A_wq": _A_in["wq"],
        "A_wo": _A_in["wo"],
        "B_x": _B_in["x"],
        "B_w1": _B_in["w1"],
        "B_b1": _B_in["b1"],
        "B_w2": _B_in["w2"],
        "B_b2": _B_in["b2"],
        "gate_w": _w((lambda *s: torch.randn(*s, dtype=torch.bfloat16) * 0.2)(512) * 16.0),
    }

def reference(A_x, A_k_cache, A_v_cache, A_wq, A_wo, B_x, B_w1, B_b1, B_w2, B_b2, gate_w):
    def _A_ref(x, k_cache, v_cache, wq, wo):
        B, Sq, D = x.shape
        Hq, Dh = 32, 128
        Hkv, Sk = k_cache.shape[1], k_cache.shape[2]
        W = min(4096, max(256, Sk // 4))
        rep = Hq // Hkv
        q = (lambda x, *d: x.permute(*d))((x @ wq).reshape(B, Sq, Hq, Dh), 0, 2, 1, 3)
        k = (lambda x, n, axis: torch.repeat_interleave(x, n, dim=axis))(k_cache[:, :, Sk - W:, :], rep, axis=1)
        v = (lambda x, n, axis: torch.repeat_interleave(x, n, dim=axis))(v_cache[:, :, Sk - W:, :], rep, axis=1)
        scores = torch.einsum("bhqd,bhkd->bhqk", q, k) * (Dh ** -0.5)
        p = _softmax(scores, axis=-1)
        o = torch.einsum("bhqk,bhkd->bhqd", p, v)
        return (lambda x, *d: x.permute(*d))(o, 0, 2, 1, 3).reshape(B, Sq, Hq * Dh) @ wo

    def _B_ref(x, w1, b1, w2, b2):
        h = torch.einsum("bsd,df->bsf", x, w1) + b1
        h = _gelu(h)
        return torch.einsum("bsf,fd->bsd", h, w2) + b2

    x = A_x
    g = _sigmoid((x * gate_w).sum(-1, keepdims=True))
    a = _A_ref(x, A_k_cache, A_v_cache, A_wq, A_wo)
    b = _B_ref(x, B_w1, B_b1, B_w2, B_b2)
    return g * a + (1 - g) * b
```

```asm
; @launch grid=(256,1,1) block=(640,1,1) lds=120064
.amdgcn_target "amdgcn-amd-amdhsa--gfx950"
.text
.globl gated_mix__sliding_block_cached__dense_activation_gelu__decode_kernel
.p2align 8
.type gated_mix__sliding_block_cached__dense_activation_gelu__decode_kernel,@function
gated_mix__sliding_block_cached__dense_activation_gelu__decode_kernel:
    s_cmp_ge_u32 s2, 256
    s_cbranch_scc1 L_end
    s_load_dwordx16 s[8:23], s[0:1], 0
    s_load_dwordx8 s[24:31], s[0:1], 64
    s_load_dwordx2 s[34:35], s[0:1], 104
    v_readfirstlane_b32 s37, v0
    v_and_b32 v1, 63, v0
    s_and_b32 s38, s2, 7
    s_lshr_b32 s39, s2, 3
    s_lshr_b32 s37, s37, 6
    s_cmp_lg_u32 s37, 0
    s_cbranch_scc1 L_others
    s_lshl_b32 s3, s38, 3
    s_and_b32 s6, s39, 7
    s_add_u32 s3, s3, s6
    s_lshl_b32 s3, s3, 7
    s_lshr_b32 s7, s39, 3
    s_lshl_b32 s4, s7, 20
    s_add_u32 s4, s4, s3
    v_lshrrev_b32 v15, 3, v1
    v_and_b32 v16, 7, v1
    v_and_b32 v17, 2, v15
    v_xor_b32 v16, v16, v17
    v_lshlrev_b32 v8, 13, v15
    v_lshl_add_u32 v8, v16, 4, v8
    v_lshlrev_b32 v9, 4, v1
    s_movk_i32 m0, 0xc00
    s_movk_i32 s46, 2048
    s_mov_b32 s47, 0x20000
    s_mov_b32 s42, 0x400000
    s_mov_b32 s43, s47
    s_mov_b32 s51, s47
    s_mov_b32 s50, 1835008
    s_mul_i32 s5, s38, 7
    s_lshr_b32 s5, s5, 1
    s_add_u32 s5, s5, s7
    s_lshl_b32 s5, s5, 7
    s_mul_i32 s6, s6, 229376
    s_add_u32 s5, s5, s6
    s_movk_i32 s7, 3584
    v_mul_u32_u24 v22, s7, v15
    v_lshl_add_u32 v22, v16, 4, v22
    s_movk_i32 s6, 16
    s_waitcnt lgkmcnt(0)
    s_mov_b64 s[44:45], s[8:9]
    s_mov_b64 s[40:41], s[14:15]
    buffer_load_dwordx4 v9, s[44:47], 0 offen lds
    buffer_load_dwordx4 v9, s[44:47], 0 offen offset:1024 lds
    s_movk_i32 m0, 0x1400
    s_mov_b64 s[48:49], s[20:21]
L_lq:
    buffer_load_dwordx4 v8, s[40:43], s4 offen nt lds
    v_xor_b32 v8, 64, v8
    s_addk_i32 m0, 0x400
    s_add_u32 s4, s4, 0x10000
    s_sub_u32 s6, s6, 1
    s_cmp_lg_u32 s6, 0
    s_cbranch_scc1 L_lq
    s_mov_b32 m0, 0x15400
    s_movk_i32 s6, 8
L_l1:
    buffer_load_dwordx4 v22, s[48:51], s5 offen nt lds
    v_xor_b32 v22, 64, v22
    s_addk_i32 m0, 0x400
    s_addk_i32 s5, 28672
    s_sub_u32 s6, s6, 1
    s_cmp_lg_u32 s6, 0
    s_cbranch_scc1 L_l1
    s_branch L_loader
L_others:
    s_cmp_eq_u32 s37, 9
    s_cbranch_scc0 L_notr0
    s_getpc_b64 s[48:49]
L_pc:
    s_sub_u32 s48, s48, L_pc-gated_mix__sliding_block_cached__dense_activation_gelu__decode_kernel
    s_subb_u32 s49, s49, 0
    v_lshlrev_b32 v15, 7, v1
    v_min_u32 v16, L_end-gated_mix__sliding_block_cached__dense_activation_gelu__decode_kernel, v15
    global_load_dword v60, v16, s[48:49]
    v_add_u32 v15, 0x2000, v15
    v_min_u32 v16, L_end-gated_mix__sliding_block_cached__dense_activation_gelu__decode_kernel, v15
    global_load_dword v61, v16, s[48:49]
    v_mov_b32 v2, 0
    v_lshlrev_b32 v8, 2, v1
    v_add_u32 v9, 0x1d400, v8
    ds_write_b32 v9, v2
    s_mov_b64 exec, 0xffff
    ds_write_b32 v8, v2
    s_mov_b64 exec, -1
L_notr0:
    s_lshr_b32 s3, s39, 4
    s_lshl_b32 s3, s3, 24
    s_lshl_b32 s4, s38, 21
    s_add_u32 s3, s3, s4
    s_add_u32 s3, s3, 0x180000
    s_lshl_b32 s5, s38, 19
    s_waitcnt lgkmcnt(0)
    s_load_dword s36, s[34:35], 0
    s_cmp_eq_u32 s37, 8
    s_cbranch_scc0 L_notlb
    s_load_dword s97, s[10:11], s3
    s_load_dword s98, s[24:25], 0
    s_load_dword s99, s[12:13], s3
    s_load_dword s100, s[16:17], s5
L_notlb:
    v_mov_b32 v2, 0
    v_mov_b32 v3, 1
    v_lshrrev_b32 v6, 4, v1
    v_and_b32 v7, 15, v1
    s_cmp_eq_u32 s37, 9
    s_cbranch_scc1 L_rrole
    s_branch L_notl
L_loader:
    v_mov_b32 v2, 0
    v_mov_b32 v3, 1
    v_lshrrev_b32 v6, 4, v1
    v_and_b32 v7, 15, v1
    v_lshlrev_b32 v14, 1, v6
    v_xor_b32 v14, v14, v7
    v_lshlrev_b32 v14, 4, v14
    v_lshl_add_u32 v14, v6, 10, v14
    v_xor_b32 v23, 128, v14
    s_mov_b32 m0, 0x5400
    s_lshr_b32 s3, s39, 4
    s_lshl_b32 s3, s3, 24
    s_lshl_b32 s4, s38, 21
    s_add_u32 s3, s3, s4
    s_and_b32 s5, s39, 15
    s_lshl_b32 s5, s5, 10
    s_add_u32 s3, s3, s5
    s_add_u32 s3, s3, 0x180000
    s_add_u32 s40, s10, s3
    s_addc_u32 s41, s11, 0
    s_mov_b32 s42, 508928
    s_mov_b32 s43, 0x20000
    s_add_u32 s44, s12, s3
    s_addc_u32 s45, s13, 0
    s_mov_b32 s46, 508928
    s_mov_b32 s47, 0x20000
    v_lshlrev_b32 v20, 8, v6
    v_xor_b32 v18, v7, v6
    v_lshl_add_u32 v10, v18, 4, v20
    v_xor_b32 v11, 64, v10
    v_xor_b32 v12, 128, v10
    v_xor_b32 v13, 192, v10
    v_lshlrev_b32 v18, 1, v6
    v_xor_b32 v18, v18, v7
    v_lshl_add_u32 v18, v18, 4, v20
    v_xor_b32 v19, 128, v18
    s_lshl_b32 s33, s38, 1
    s_lshr_b32 s4, s39, 4
    s_add_u32 s33, s33, s4
    s_mul_i32 s33, s33, 2
    s_and_b32 s33, s33, 31
    s_lshl_b32 s33, s33, 14
    s_mov_b32 s32, s33
    s_waitcnt vmcnt(19)
    buffer_load_dwordx4 v10, s[40:43], s32 offen nt lds
    s_mov_b32 m0, 0x5800
    s_add_u32 s32, s32, 0x4000
    s_and_b32 s32, s32, 0x7ffff
    s_waitcnt vmcnt(19)
    buffer_load_dwordx4 v11, s[40:43], s32 offen nt lds
    s_mov_b32 m0, 0x5c00
    s_add_u32 s32, s32, 0x4000
    s_and_b32 s32, s32, 0x7ffff
    s_waitcnt vmcnt(19)
    buffer_load_dwordx4 v12, s[40:43], s32 offen nt lds
    s_mov_b32 m0, 0x6000
    s_add_u32 s32, s32, 0x4000
    s_and_b32 s32, s32, 0x7ffff
    s_waitcnt vmcnt(19)
    buffer_load_dwordx4 v13, s[40:43], s32 offen nt lds
    s_mov_b32 m0, 0x6400
    s_add_u32 s32, s32, 0x4000
    s_and_b32 s32, s32, 0x7ffff
    s_waitcnt vmcnt(19)
    buffer_load_dwordx4 v10, s[40:43], s32 offen nt lds
    s_mov_b32 m0, 0x6800
    s_add_u32 s32, s32, 0x4000
    s_and_b32 s32, s32, 0x7ffff
    s_waitcnt vmcnt(19)
    buffer_load_dwordx4 v11, s[40:43], s32 offen nt lds
    s_mov_b32 m0, 0x6c00
    s_add_u32 s32, s32, 0x4000
    s_and_b32 s32, s32, 0x7ffff
    s_waitcnt vmcnt(19)
    buffer_load_dwordx4 v12, s[40:43], s32 offen nt lds
    s_mov_b32 m0, 0x7000
    s_add_u32 s32, s32, 0x4000
    s_and_b32 s32, s32, 0x7ffff
    s_waitcnt vmcnt(19)
    buffer_load_dwordx4 v13, s[40:43], s32 offen nt lds
    s_mov_b32 m0, 0x7400
    s_add_u32 s32, s32, 0x4000
    s_and_b32 s32, s32, 0x7ffff
    s_waitcnt vmcnt(19)
    buffer_load_dwordx4 v10, s[40:43], s32 offen nt lds
    s_mov_b32 m0, 0x7800
    s_add_u32 s32, s32, 0x4000
    s_and_b32 s32, s32, 0x7ffff
    s_waitcnt vmcnt(19)
    buffer_load_dwordx4 v11, s[40:43], s32 offen nt lds
    s_mov_b32 m0, 0x7c00
    s_add_u32 s32, s32, 0x4000
    s_and_b32 s32, s32, 0x7ffff
    s_waitcnt vmcnt(19)
    buffer_load_dwordx4 v12, s[40:43], s32 offen nt lds
    s_mov_b32 m0, 0x8000
    s_add_u32 s32, s32, 0x4000
    s_and_b32 s32, s32, 0x7ffff
    s_waitcnt vmcnt(19)
    s_barrier
    buffer_load_dwordx4 v13, s[40:43], s32 offen nt lds
    s_mov_b32 m0, 0x8400
    s_add_u32 s32, s32, 0x4000
    s_and_b32 s32, s32, 0x7ffff
    s_waitcnt vmcnt(19)
    buffer_load_dwordx4 v10, s[40:43], s32 offen nt lds
    s_mov_b32 m0, 0x8800
    s_add_u32 s32, s32, 0x4000
    s_and_b32 s32, s32, 0x7ffff
    s_waitcnt vmcnt(19)
    buffer_load_dwordx4 v11, s[40:43], s32 offen nt lds
    s_mov_b32 m0, 0x8c00
    s_add_u32 s32, s32, 0x4000
    s_and_b32 s32, s32, 0x7ffff
    s_waitcnt vmcnt(19)
    buffer_load_dwordx4 v12, s[40:43], s32 offen nt lds
    s_mov_b32 m0, 0x9000
    s_add_u32 s32, s32, 0x4000
    s_and_b32 s32, s32, 0x7ffff
    s_waitcnt vmcnt(19)
    buffer_load_dwordx4 v13, s[40:43], s32 offen nt lds
    s_mov_b32 m0, 0x9400
    s_add_u32 s32, s32, 0x4000
    s_and_b32 s32, s32, 0x7ffff
    s_waitcnt vmcnt(19)
    buffer_load_dwordx4 v10, s[40:43], s32 offen nt lds
    s_mov_b32 m0, 0x9800
    s_add_u32 s32, s32, 0x4000
    s_and_b32 s32, s32, 0x7ffff
    s_waitcnt vmcnt(19)
    buffer_load_dwordx4 v11, s[40:43], s32 offen nt lds
    s_mov_b32 m0, 0x9c00
    s_add_u32 s32, s32, 0x4000
    s_and_b32 s32, s32, 0x7ffff
    s_waitcnt vmcnt(19)
    buffer_load_dwordx4 v12, s[40:43], s32 offen nt lds
    s_mov_b32 m0, 0xa000
    s_add_u32 s32, s32, 0x4000
    s_and_b32 s32, s32, 0x7ffff
    s_waitcnt vmcnt(19)
    v_mov_b32 v17, 26
    s_mov_b64 exec, 1
    ds_write_b32 v2, v17 offset:8
    s_mov_b64 exec, -1
    buffer_load_dwordx4 v13, s[40:43], s32 offen nt lds
    s_mov_b32 m0, 0xa400
    s_add_u32 s32, s32, 0x4000
    s_and_b32 s32, s32, 0x7ffff
    s_waitcnt vmcnt(19)
    buffer_load_dwordx4 v10, s[40:43], s32 offen nt lds
    s_mov_b32 m0, 0xa800
    s_add_u32 s32, s32, 0x4000
    s_and_b32 s32, s32, 0x7ffff
    s_waitcnt vmcnt(19)
    buffer_load_dwordx4 v11, s[40:43], s32 offen nt lds
    s_mov_b32 m0, 0xac00
    s_add_u32 s32, s32, 0x4000
    s_and_b32 s32, s32, 0x7ffff
    s_waitcnt vmcnt(19)
    buffer_load_dwordx4 v12, s[40:43], s32 offen nt lds
    s_mov_b32 m0, 0xb000
    s_add_u32 s32, s32, 0x4000
    s_and_b32 s32, s32, 0x7ffff
    s_waitcnt vmcnt(19)
    buffer_load_dwordx4 v13, s[40:43], s32 offen nt lds
    s_mov_b32 m0, 0xb400
    s_add_u32 s32, s32, 0x4000
    s_and_b32 s32, s32, 0x7ffff
    s_waitcnt vmcnt(19)
    buffer_load_dwordx4 v10, s[40:43], s32 offen nt lds
    s_mov_b32 m0, 0xb800
    s_add_u32 s32, s32, 0x4000
    s_and_b32 s32, s32, 0x7ffff
    s_waitcnt vmcnt(19)
    v_mov_b32 v17, 32
    s_mov_b64 exec, 1
    ds_write_b32 v2, v17 offset:8
    s_mov_b64 exec, -1
    buffer_load_dwordx4 v11, s[40:43], s32 offen nt lds
    s_mov_b32 m0, 0xbc00
    s_add_u32 s32, s32, 0x4000
    s_and_b32 s32, s32, 0x7ffff
    s_waitcnt vmcnt(19)
    buffer_load_dwordx4 v12, s[40:43], s32 offen nt lds
    s_mov_b32 m0, 0xc000
    s_add_u32 s32, s32, 0x4000
    s_and_b32 s32, s32, 0x7ffff
    s_waitcnt vmcnt(19)
    buffer_load_dwordx4 v13, s[40:43], s32 offen nt lds
    s_mov_b32 m0, 0xc400
    s_add_u32 s32, s32, 0x4000
    s_and_b32 s32, s32, 0x7ffff
    s_waitcnt vmcnt(19)
    buffer_load_dwordx4 v10, s[40:43], s32 offen nt lds
    s_mov_b32 m0, 0xc800
    s_add_u32 s32, s32, 0x4000
    s_and_b32 s32, s32, 0x7ffff
    s_waitcnt vmcnt(19)
    buffer_load_dwordx4 v11, s[40:43], s32 offen nt lds
    s_mov_b32 m0, 0xcc00
    s_add_u32 s32, s32, 0x4000
    s_and_b32 s32, s32, 0x7ffff
    s_waitcnt vmcnt(19)
    buffer_load_dwordx4 v12, s[40:43], s32 offen nt lds
    s_mov_b32 m0, 0xd000
    s_add_u32 s32, s32, 0x4000
    s_and_b32 s32, s32, 0x7ffff
    s_waitcnt vmcnt(19)
    v_mov_b32 v17, 38
    s_mov_b64 exec, 1
    ds_write_b32 v2, v17 offset:8
    s_mov_b64 exec, -1
    buffer_load_dwordx4 v13, s[40:43], s32 offen nt lds
    s_mul_i32 s3, s38, 224
    s_lshr_b32 s4, s39, 2
    s_mul_i32 s4, s4, 28
    s_add_u32 s3, s3, s4
    s_lshl_b32 s3, s3, 10
    s_and_b32 s4, s39, 3
    s_lshl_b32 s4, s4, 8
    s_add_u32 s3, s3, s4
    s_add_u32 s60, s24, s3
    s_addc_u32 s61, s25, 0
    s_mov_b32 s62, 27904
    s_mov_b32 s63, 0x20000
    s_mov_b32 m0, 0x1d000
    s_mov_b32 s4, 28672
    s_waitcnt vmcnt(19)
    buffer_load_dwordx4 v23, s[60:63], s4 offen nt lds
    s_mov_b32 m0, 0x1b400
    s_mov_b32 s4, 0
    s_waitcnt vmcnt(19)
    buffer_load_dwordx4 v14, s[60:63], s4 offen nt lds
    s_mov_b32 m0, 0x1b800
    s_mov_b32 s4, 4096
    s_waitcnt vmcnt(19)
    buffer_load_dwordx4 v14, s[60:63], s4 offen nt lds
    s_mov_b32 m0, 0x1bc00
    s_mov_b32 s4, 8192
    s_waitcnt vmcnt(19)
    buffer_load_dwordx4 v23, s[60:63], s4 offen nt lds
    s_mov_b32 m0, 0x1c000
    s_mov_b32 s4, 12288
    s_waitcnt vmcnt(19)
    buffer_load_dwordx4 v23, s[60:63], s4 offen nt lds
    s_mov_b32 m0, 0x1c400
    s_mov_b32 s4, 16384
    s_waitcnt vmcnt(19)
    buffer_load_dwordx4 v14, s[60:63], s4 offen nt lds
    s_mov_b32 m0, 0x1c800
    s_mov_b32 s4, 20480
    s_waitcnt vmcnt(19)
    v_mov_b32 v17, 45
    s_mov_b64 exec, 1
    ds_write_b32 v2, v17 offset:8
    s_mov_b64 exec, -1
    buffer_load_dwordx4 v14, s[60:63], s4 offen nt lds
    s_mov_b32 m0, 0x1cc00
    s_mov_b32 s4, 24576
    s_waitcnt vmcnt(19)
    buffer_load_dwordx4 v23, s[60:63], s4 offen nt lds
    s_mov_b32 m0, 0xd400
    s_mov_b32 s32, s33
    s_waitcnt vmcnt(19)
    buffer_load_dwordx4 v18, s[44:47], s32 offen nt lds
    s_mov_b32 m0, 0xd800
    s_add_u32 s32, s32, 0x4000
    s_and_b32 s32, s32, 0x7ffff
    s_waitcnt vmcnt(19)
    buffer_load_dwordx4 v18, s[44:47], s32 offen nt lds
    s_mov_b32 m0, 0xdc00
    s_add_u32 s32, s32, 0x4000
    s_and_b32 s32, s32, 0x7ffff
    s_waitcnt vmcnt(19)
    buffer_load_dwordx4 v19, s[44:47], s32 offen nt lds
    s_mov_b32 m0, 0xe000
    s_add_u32 s32, s32, 0x4000
    s_and_b32 s32, s32, 0x7ffff
    s_waitcnt vmcnt(19)
    v_mov_b32 v17, 50
    s_mov_b64 exec, 1
    ds_write_b32 v2, v17 offset:8
    s_mov_b64 exec, -1
    buffer_load_dwordx4 v19, s[44:47], s32 offen nt lds
    s_mov_b32 m0, 0xe400
    s_add_u32 s32, s32, 0x4000
    s_and_b32 s32, s32, 0x7ffff
    s_waitcnt vmcnt(19)
    buffer_load_dwordx4 v18, s[44:47], s32 offen nt lds
    s_mov_b32 m0, 0xe800
    s_add_u32 s32, s32, 0x4000
    s_and_b32 s32, s32, 0x7ffff
    s_waitcnt vmcnt(19)
    buffer_load_dwordx4 v18, s[44:47], s32 offen nt lds
    s_mov_b32 m0, 0xec00
    s_add_u32 s32, s32, 0x4000
    s_and_b32 s32, s32, 0x7ffff
    s_waitcnt vmcnt(19)
    v_mov_b32 v17, 53
    s_mov_b64 exec, 1
    ds_write_b32 v2, v17 offset:8
    s_mov_b64 exec, -1
    buffer_load_dwordx4 v19, s[44:47], s32 offen nt lds
    s_mov_b32 m0, 0xf000
    s_add_u32 s32, s32, 0x4000
    s_and_b32 s32, s32, 0x7ffff
    s_waitcnt vmcnt(19)
    buffer_load_dwordx4 v19, s[44:47], s32 offen nt lds
    s_mov_b32 m0, 0xf400
    s_add_u32 s32, s32, 0x4000
    s_and_b32 s32, s32, 0x7ffff
    s_waitcnt vmcnt(19)
    buffer_load_dwordx4 v18, s[44:47], s32 offen nt lds
    s_mov_b32 m0, 0xf800
    s_add_u32 s32, s32, 0x4000
    s_and_b32 s32, s32, 0x7ffff
    s_waitcnt vmcnt(19)
    buffer_load_dwordx4 v18, s[44:47], s32 offen nt lds
    s_mov_b32 m0, 0xfc00
    s_add_u32 s32, s32, 0x4000
    s_and_b32 s32, s32, 0x7ffff
    s_waitcnt vmcnt(19)
    buffer_load_dwordx4 v19, s[44:47], s32 offen nt lds
    s_mov_b32 m0, 0x10000
    s_add_u32 s32, s32, 0x4000
    s_and_b32 s32, s32, 0x7ffff
    s_waitcnt vmcnt(19)
    v_mov_b32 v17, 58
    s_mov_b64 exec, 1
    ds_write_b32 v2, v17 offset:8
    s_mov_b64 exec, -1
    buffer_load_dwordx4 v19, s[44:47], s32 offen nt lds
    s_mov_b32 m0, 0x10400
    s_add_u32 s32, s32, 0x4000
    s_and_b32 s32, s32, 0x7ffff
    s_waitcnt vmcnt(19)
    buffer_load_dwordx4 v18, s[44:47], s32 offen nt lds
    s_mov_b32 m0, 0x10800
    s_add_u32 s32, s32, 0x4000
    s_and_b32 s32, s32, 0x7ffff
    s_waitcnt vmcnt(19)
    buffer_load_dwordx4 v18, s[44:47], s32 offen nt lds
    s_mov_b32 m0, 0x10c00
    s_add_u32 s32, s32, 0x4000
    s_and_b32 s32, s32, 0x7ffff
    s_waitcnt vmcnt(19)
    buffer_load_dwordx4 v19, s[44:47], s32 offen nt lds
    s_mov_b32 m0, 0x11000
    s_add_u32 s32, s32, 0x4000
    s_and_b32 s32, s32, 0x7ffff
    s_waitcnt vmcnt(19)
    buffer_load_dwordx4 v19, s[44:47], s32 offen nt lds
    s_mov_b32 m0, 0x11400
    s_add_u32 s32, s32, 0x4000
    s_and_b32 s32, s32, 0x7ffff
    s_waitcnt vmcnt(19)
    buffer_load_dwordx4 v18, s[44:47], s32 offen nt lds
    s_mov_b32 m0, 0x11800
    s_add_u32 s32, s32, 0x4000
    s_and_b32 s32, s32, 0x7ffff
    s_waitcnt vmcnt(19)
    buffer_load_dwordx4 v18, s[44:47], s32 offen nt lds
    s_mov_b32 m0, 0x11c00
    s_add_u32 s32, s32, 0x4000
    s_and_b32 s32, s32, 0x7ffff
    s_waitcnt vmcnt(19)
    buffer_load_dwordx4 v19, s[44:47], s32 offen nt lds
    s_mov_b32 m0, 0x12000
    s_add_u32 s32, s32, 0x4000
    s_and_b32 s32, s32, 0x7ffff
    s_waitcnt vmcnt(19)
    v_mov_b32 v17, 66
    s_mov_b64 exec, 1
    ds_write_b32 v2, v17 offset:8
    s_mov_b64 exec, -1
    buffer_load_dwordx4 v19, s[44:47], s32 offen nt lds
    s_mov_b32 m0, 0x12400
    s_add_u32 s32, s32, 0x4000
    s_and_b32 s32, s32, 0x7ffff
    s_waitcnt vmcnt(19)
    buffer_load_dwordx4 v18, s[44:47], s32 offen nt lds
    s_mov_b32 m0, 0x12800
    s_add_u32 s32, s32, 0x4000
    s_and_b32 s32, s32, 0x7ffff
    s_waitcnt vmcnt(19)
    buffer_load_dwordx4 v18, s[44:47], s32 offen nt lds
    s_mov_b32 m0, 0x12c00
    s_add_u32 s32, s32, 0x4000
    s_and_b32 s32, s32, 0x7ffff
    s_waitcnt vmcnt(19)
    buffer_load_dwordx4 v19, s[44:47], s32 offen nt lds
    s_mov_b32 m0, 0x13000
    s_add_u32 s32, s32, 0x4000
    s_and_b32 s32, s32, 0x7ffff
    s_waitcnt vmcnt(19)
    buffer_load_dwordx4 v19, s[44:47], s32 offen nt lds
    s_mov_b32 m0, 0x13400
    s_add_u32 s32, s32, 0x4000
    s_and_b32 s32, s32, 0x7ffff
    s_waitcnt vmcnt(19)
    buffer_load_dwordx4 v18, s[44:47], s32 offen nt lds
    s_mov_b32 m0, 0x13800
    s_add_u32 s32, s32, 0x4000
    s_and_b32 s32, s32, 0x7ffff
    s_waitcnt vmcnt(19)
    buffer_load_dwordx4 v18, s[44:47], s32 offen nt lds
    s_mov_b32 m0, 0x13c00
    s_add_u32 s32, s32, 0x4000
    s_and_b32 s32, s32, 0x7ffff
    s_waitcnt vmcnt(19)
    buffer_load_dwordx4 v19, s[44:47], s32 offen nt lds
    s_mov_b32 m0, 0x14000
    s_add_u32 s32, s32, 0x4000
    s_and_b32 s32, s32, 0x7ffff
    s_waitcnt vmcnt(19)
    buffer_load_dwordx4 v19, s[44:47], s32 offen nt lds
    s_mov_b32 m0, 0x14400
    s_add_u32 s32, s32, 0x4000
    s_and_b32 s32, s32, 0x7ffff
    s_waitcnt vmcnt(19)
    buffer_load_dwordx4 v18, s[44:47], s32 offen nt lds
    s_mov_b32 m0, 0x14800
    s_add_u32 s32, s32, 0x4000
    s_and_b32 s32, s32, 0x7ffff
    s_waitcnt vmcnt(19)
    buffer_load_dwordx4 v18, s[44:47], s32 offen nt lds
    s_mov_b32 m0, 0x14c00
    s_add_u32 s32, s32, 0x4000
    s_and_b32 s32, s32, 0x7ffff
    s_waitcnt vmcnt(19)
    buffer_load_dwordx4 v19, s[44:47], s32 offen nt lds
    s_mov_b32 m0, 0x15000
    s_add_u32 s32, s32, 0x4000
    s_and_b32 s32, s32, 0x7ffff
    s_waitcnt vmcnt(19)
    buffer_load_dwordx4 v19, s[44:47], s32 offen nt lds
    s_lshl_b32 s3, s38, 19
    s_lshr_b32 s4, s39, 2
    s_lshl_b32 s4, s4, 16
    s_add_u32 s3, s3, s4
    s_and_b32 s4, s39, 3
    s_lshl_b32 s4, s4, 8
    s_add_u32 s3, s3, s4
    s_add_u32 s56, s16, s3
    s_addc_u32 s57, s17, 0
    s_mov_b32 s58, 64768
    s_mov_b32 s59, 0x20000
    s_mov_b32 m0, 0x17400
    s_mov_b32 s4, 0
    s_waitcnt vmcnt(19)
    buffer_load_dwordx4 v14, s[56:59], s4 offen nt lds
    s_mov_b32 m0, 0x17800
    s_mov_b32 s4, 4096
    s_waitcnt vmcnt(19)
    buffer_load_dwordx4 v14, s[56:59], s4 offen nt lds
    s_mov_b32 m0, 0x17c00
    s_mov_b32 s4, 8192
    s_waitcnt vmcnt(19)
    buffer_load_dwordx4 v23, s[56:59], s4 offen nt lds
    s_mov_b32 m0, 0x18000
    s_mov_b32 s4, 12288
    s_waitcnt vmcnt(19)
    buffer_load_dwordx4 v23, s[56:59], s4 offen nt lds
    s_mov_b32 m0, 0x18400
    s_mov_b32 s4, 16384
    s_waitcnt vmcnt(19)
    buffer_load_dwordx4 v14, s[56:59], s4 offen nt lds
    s_mov_b32 m0, 0x18800
    s_mov_b32 s4, 20480
    s_waitcnt vmcnt(19)
    buffer_load_dwordx4 v14, s[56:59], s4 offen nt lds
    s_mov_b32 m0, 0x18c00
    s_mov_b32 s4, 24576
    s_waitcnt vmcnt(19)
    buffer_load_dwordx4 v23, s[56:59], s4 offen nt lds
    s_mov_b32 m0, 0x19000
    s_mov_b32 s4, 28672
    s_waitcnt vmcnt(19)
    buffer_load_dwordx4 v23, s[56:59], s4 offen nt lds
    s_mov_b32 m0, 0x19400
    s_mov_b32 s4, 32768
    s_waitcnt vmcnt(19)
    buffer_load_dwordx4 v14, s[56:59], s4 offen nt lds
    s_mov_b32 m0, 0x19800
    s_mov_b32 s4, 36864
    s_waitcnt vmcnt(19)
    buffer_load_dwordx4 v14, s[56:59], s4 offen nt lds
    s_mov_b32 m0, 0x19c00
    s_mov_b32 s4, 40960
    s_waitcnt vmcnt(19)
    buffer_load_dwordx4 v23, s[56:59], s4 offen nt lds
    s_mov_b32 m0, 0x1a000
    s_mov_b32 s4, 45056
    s_waitcnt vmcnt(19)
    v_mov_b32 v17, 90
    s_mov_b64 exec, 1
    ds_write_b32 v2, v17 offset:8
    s_mov_b64 exec, -1
    buffer_load_dwordx4 v23, s[56:59], s4 offen nt lds
    s_mov_b32 m0, 0x1a400
    s_mov_b32 s4, 49152
    s_waitcnt vmcnt(19)
    buffer_load_dwordx4 v14, s[56:59], s4 offen nt lds
    s_mov_b32 m0, 0x1a800
    s_mov_b32 s4, 53248
    s_waitcnt vmcnt(19)
    buffer_load_dwordx4 v14, s[56:59], s4 offen nt lds
    s_mov_b32 m0, 0x1ac00
    s_mov_b32 s4, 57344
    s_waitcnt vmcnt(19)
    buffer_load_dwordx4 v23, s[56:59], s4 offen nt lds
    s_mov_b32 m0, 0x1b000
    s_mov_b32 s4, 61440
    s_waitcnt vmcnt(19)
    buffer_load_dwordx4 v23, s[56:59], s4 offen nt lds
    s_waitcnt vmcnt(16)
    v_mov_b32 v17, 98
    s_mov_b64 exec, 1
    ds_write_b32 v2, v17 offset:8
    s_mov_b64 exec, -1
    s_waitcnt vmcnt(0)
    v_mov_b32 v17, 114
    s_mov_b64 exec, 1
    ds_write_b32 v2, v17 offset:8
    s_mov_b64 exec, -1
    s_endpgm
L_notl:
    s_getreg_b32 s49, hwreg(HW_REG_XCC_ID, 0, 4)
    s_mov_b32 s52, s34
    s_mov_b32 s53, s35
    s_mov_b32 s54, 16777216
    s_mov_b32 s55, 0x20000
    s_mov_b32 s44, 0x05030201
    s_mov_b32 s45, 0x06050302
    s_mov_b32 s46, 0x07060503
    s_mov_b32 s47, 0x0504030c
    s_mov_b32 s48, 0x0403020c
    s_cmp_ge_u32 s37, 5
    s_cbranch_scc1 L_kv
    s_sub_u32 s37, s37, 1
    s_lshl_b32 s3, s38, 14
    s_bfe_u32 s4, s39, 0x20001
    s_lshl_b32 s4, s4, 11
    s_add_u32 s3, s3, s4
    s_lshr_b32 s4, s39, 3
    s_lshl_b32 s4, s4, 9
    s_add_u32 s3, s3, s4
    s_and_b32 s4, s39, 1
    s_lshl_b32 s4, s4, 8
    s_add_u32 s3, s3, s4
    s_lshl_b32 s4, s37, 6
    s_add_u32 s3, s3, s4
    s_add_u32 s3, s3, 0x10000
    s_xor_b32 s5, s3, 0x400000
    v_bfe_u32 v60, v1, 0, 1
    v_lshlrev_b32 v60, 13, v60
    v_bfe_u32 v5, v1, 4, 2
    v_lshl_add_u32 v60, v5, 4, v60
    v_bfe_u32 v10, v1, 0, 1
    v_lshlrev_b32 v10, 10, v10
    v_bfe_u32 v5, v1, 4, 2
    v_lshl_add_u32 v10, v5, 4, v10
    s_lshr_b32 s4, s39, 3
    s_lshl_b32 s4, s4, 8
    v_add_u32 v11, s4, v10
    s_lshl_b32 s4, s37, 5
    v_bfe_u32 v13, v1, 3, 1
    v_lshlrev_b32 v13, 5, v13
    v_bfe_u32 v5, v1, 4, 1
    v_lshl_add_u32 v13, v5, 6, v13
    v_xor_b32 v13, s4, v13
    v_bfe_u32 v12, v1, 4, 2
    v_lshlrev_b32 v12, 10, v12
    v_bfe_u32 v5, v1, 2, 2
    v_lshl_add_u32 v12, v5, 7, v12
    v_bfe_u32 v5, v1, 0, 2
    v_lshl_add_u32 v12, v5, 3, v12
    v_add_u32 v12, v12, v13
    s_mov_b32 s56, 0x00030003
    s_mov_b32 s57, 0x00030003
    s_waitcnt lgkmcnt(0)
    s_mul_i32 s36, s36, 0x9E3779B1
    s_add_u32 s36, s36, 0x7F4A7C15
    s_xor_b32 s4, s36, s49
    v_mov_b32 v59, s4
    s_barrier
    ds_read_b128 v[16:19], v11 offset:3072
    ds_read_b64_tr_b16 v[36:37], v12 offset:5120
    ds_read_b64_tr_b16 v[38:39], v12 offset:5632
    ds_read_b128 v[20:23], v11 offset:3136
    ds_read_b64_tr_b16 v[40:41], v12 offset:9216
    ds_read_b64_tr_b16 v[42:43], v12 offset:9728
    ds_read_b128 v[24:27], v11 offset:3200
    ds_read_b64_tr_b16 v[44:45], v12 offset:13312
    ds_read_b64_tr_b16 v[46:47], v12 offset:13824
    ds_read_b128 v[28:31], v11 offset:3264
    ds_read_b64_tr_b16 v[48:49], v12 offset:17408
    ds_read_b64_tr_b16 v[50:51], v12 offset:17920
    s_waitcnt lgkmcnt(9)
    v_mfma_f32_16x16x32_bf16 v[52:55], v[36:39], v[16:19], 0
    s_waitcnt lgkmcnt(6)
    v_mfma_f32_16x16x32_bf16 v[52:55], v[40:43], v[20:23], v[52:55]
    s_waitcnt lgkmcnt(3)
    v_mfma_f32_16x16x32_bf16 v[52:55], v[44:47], v[24:27], v[52:55]
    s_waitcnt lgkmcnt(0)
    v_mfma_f32_16x16x32_bf16 v[52:55], v[48:51], v[28:31], v[52:55]
    s_nop 7
    v_add_u32 v52, 0x80, v52
    v_add_u32 v53, 0x80, v53
    v_add_u32 v54, 0x80, v54
    v_add_u32 v55, 0x80, v55
    v_perm_b32 v56, v53, v52, s44
    v_perm_b32 v57, v54, v53, s45
    v_perm_b32 v58, v55, v54, s46
    s_mov_b64 exec, s[56:57]
    buffer_store_dwordx4 v[56:59], v60, s[52:55], s3 offen
    buffer_store_dwordx4 v[56:59], v60, s[52:55], s5 offen sc1
    s_mov_b64 exec, -1
    s_and_b32 s4, s39, 7
    s_lshl_b32 s4, s4, 7
    v_add_u32 v11, s4, v10
    s_mov_b32 s4, 87040
    v_add_u32 v13, s4, v12
    ds_read_b128 v[16:19], v11 offset:3072
    ds_read_b128 v[20:23], v11 offset:3136
    s_lshl_b32 s63, s38, 3
    s_and_b32 s4, s39, 7
    s_add_u32 s63, s63, s4
    s_mul_i32 s63, s63, 2176
    s_mov_b32 s62, s63
    s_lshr_b32 s4, s39, 3
    s_lshl_b32 s4, s4, 8
    s_add_u32 s62, s62, s4
    s_lshl_b32 s4, s37, 6
    s_add_u32 s62, s62, s4
    s_add_u32 s62, s62, 0x30000
    v_mov_b32 v79, s36
    s_mov_b32 s7, 2000000
L_lw_1:
    ds_read_b32 v4, v2 offset:8
    s_waitcnt lgkmcnt(0)
    v_readfirstlane_b32 s6, v4
    s_cmp_ge_u32 s6, 26
    s_cbranch_scc1 L_ld_2
    s_sleep 1
    s_sub_u32 s7, s7, 1
    s_cmp_lg_u32 s7, 0
    s_cbranch_scc1 L_lw_1
L_ld_2:
    ds_read_b64_tr_b16 v[24:25], v13 offset:0
    ds_read_b64_tr_b16 v[26:27], v13 offset:512
    ds_read_b64_tr_b16 v[28:29], v13 offset:4096
    ds_read_b64_tr_b16 v[30:31], v13 offset:4608
    s_waitcnt lgkmcnt(0)
    v_mfma_f32_16x16x32_bf16 v[52:55], v[24:27], v[16:19], 0
    v_mfma_f32_16x16x32_bf16 v[52:55], v[28:31], v[20:23], v[52:55]
    s_nop 7
    v_add_u32 v52, 0x80, v52
    v_add_u32 v53, 0x80, v53
    v_add_u32 v54, 0x80, v54
    v_add_u32 v55, 0x80, v55
    v_perm_b32 v76, v53, v52, s44
    v_perm_b32 v77, v54, v53, s45
    v_perm_b32 v78, v55, v54, s46
    s_mov_b64 exec, s[56:57]
    buffer_store_dwordx4 v[76:79], v10, s[52:55], s62 offen
    s_mov_b64 exec, -1
    v_bfe_u32 v64, v1, 3, 3
    v_lshlrev_b32 v64, 11, v64
    v_bfe_u32 v5, v1, 3, 3
    v_lshl_add_u32 v64, v5, 7, v64
    v_bfe_u32 v5, v1, 0, 3
    v_lshl_add_u32 v64, v5, 4, v64
    s_lshl_b32 s63, s38, 5
    s_lshr_b32 s4, s37, 1
    s_lshl_b32 s4, s4, 4
    s_add_u32 s63, s63, s4
    s_mul_i32 s63, s63, 2176
    s_mov_b32 s58, s63
    s_lshr_b32 s4, s39, 2
    s_lshl_b32 s4, s4, 8
    s_add_u32 s58, s58, s4
    s_and_b32 s4, s37, 1
    s_lshl_b32 s4, s4, 7
    s_add_u32 s58, s58, s4
    s_add_u32 s58, s58, 0x80000
    s_add_u32 s59, s58, 17408
    v_bfe_u32 v65, v1, 3, 3
    v_lshlrev_b32 v65, 4, v65
    v_bfe_u32 v5, v1, 0, 1
    v_lshl_add_u32 v65, v5, 7, v65
    s_lshl_b32 s60, s38, 11
    s_lshr_b32 s4, s37, 1
    s_lshl_b32 s4, s4, 10
    s_add_u32 s60, s60, s4
    s_lshr_b32 s4, s39, 3
    s_lshl_b32 s4, s4, 8
    s_add_u32 s60, s60, s4
    s_add_u32 s60, s60, 0x60000
    s_lshl_b32 s4, s37, 6
    v_bfe_u32 v66, v1, 0, 3
    v_lshlrev_b32 v66, 3, v66
    v_bfe_u32 v5, v1, 4, 2
    v_lshl_add_u32 v66, v5, 1, v66
    v_add_u32 v66, s4, v66
    v_bfe_u32 v67, v1, 0, 1
    v_lshlrev_b32 v67, 7, v67
    v_bfe_u32 v5, v1, 4, 2
    v_lshl_add_u32 v67, v5, 4, v67
    v_bfe_u32 v68, v1, 0, 1
    v_lshlrev_b32 v68, 6, v68
    v_bfe_u32 v5, v1, 4, 2
    v_lshl_add_u32 v68, v5, 4, v68
    v_bfe_u32 v71, v1, 2, 2
    v_lshlrev_b32 v71, 5, v71
    v_bfe_u32 v5, v1, 4, 1
    v_lshl_add_u32 v71, v5, 7, v71
    s_lshl_b32 s4, s37, 6
    v_xor_b32 v71, s4, v71
    s_mov_b32 s4, 95232
    v_bfe_u32 v69, v1, 4, 2
    v_lshlrev_b32 v69, 11, v69
    v_bfe_u32 v5, v1, 2, 2
    v_lshl_add_u32 v69, v5, 8, v69
    v_bfe_u32 v5, v1, 0, 2
    v_lshl_add_u32 v69, v5, 3, v69
    v_add_u32 v69, s4, v69
    v_add_u32 v69, v69, v71
    v_xor_b32 v71, 32, v69
    s_lshl_b32 s61, s38, 15
    s_lshl_b32 s4, s39, 10
    s_add_u32 s61, s61, s4
    s_lshl_b32 s4, s37, 8
    s_add_u32 s61, s61, s4
    s_lshl_b32 s4, s38, 10
    s_add_u32 s61, s61, s4
    s_lshr_b32 s4, s39, 2
    s_lshl_b32 s4, s4, 7
    s_add_u32 s61, s61, s4
    s_add_u32 s61, s61, 0x120000
    v_bfe_u32 v70, v1, 4, 2
    v_lshlrev_b32 v70, 6, v70
    v_bfe_u32 v5, v1, 0, 2
    v_lshl_add_u32 v70, v5, 4, v70
    v_bfe_u32 v73, v1, 0, 1
    v_lshlrev_b32 v73, 2, v73
    v_bfe_u32 v5, v1, 1, 1
    v_cmp_eq_u32 s[42:43], 1, v5
    v_mov_b32 v123, s36
    s_mov_b32 s40, 0x000f000f
    s_mov_b32 s41, 0x000f000f
    s_mov_b32 s50, 0x00ff00ff
    s_mov_b32 s51, 0x00ff00ff
    s_mov_b32 s7, 2000000
L_lw_3:
    ds_read_b32 v4, v2 offset:0
    ds_read_b32 v5, v2 offset:4
    s_waitcnt lgkmcnt(0)
    v_readfirstlane_b32 s6, v4
    s_cmp_ge_u32 s6, 4
    s_cbranch_scc1 L_ld_4
    s_sleep 1
    s_sub_u32 s7, s7, 1
    s_cmp_lg_u32 s7, 0
    s_cbranch_scc1 L_lw_3
L_ld_4:
    v_readfirstlane_b32 s4, v5
    s_cmp_eq_u32 s4, 0
    s_cbranch_scc1 L_w_loc
    s_xor_b32 s62, s62, 0x400000
    s_mov_b64 exec, s[56:57]
    buffer_store_dwordx4 v[76:79], v10, s[52:55], s62 offen sc1
    s_mov_b64 exec, -1
L_w_loc:
    s_mov_b32 s7, 2000000
L_lw_5:
    ds_read_b32 v4, v2 offset:8
    s_waitcnt lgkmcnt(0)
    v_readfirstlane_b32 s6, v4
    s_cmp_ge_u32 s6, 66
    s_cbranch_scc1 L_ld_6
    s_sleep 1
    s_sub_u32 s7, s7, 1
    s_cmp_lg_u32 s7, 0
    s_cbranch_scc1 L_lw_5
L_ld_6:
    ds_read_b64_tr_b16 v[48:49], v69 offset:16384
    ds_read_b64_tr_b16 v[50:51], v69 offset:17408
    ds_read_b64_tr_b16 v[52:53], v71 offset:16384
    ds_read_b64_tr_b16 v[54:55], v71 offset:17408
    s_mov_b32 s7, 2000000
L_lw_7:
    ds_read_b32 v4, v2 offset:28
    ds_read_b128 v[92:95], v68 offset:384
    ds_read_b32 v80, v73 offset:64
    ds_read_b32 v81, v73 offset:72
    s_waitcnt lgkmcnt(0)
    v_readfirstlane_b32 s6, v4
    s_cmp_ge_u32 s6, 1
    s_cbranch_scc1 L_ld_8
    s_sleep 1
    s_sub_u32 s7, s7, 1
    s_cmp_lg_u32 s7, 0
    s_cbranch_scc1 L_lw_7
L_ld_8:
    v_mfma_f32_16x16x32_bf16 v[104:107], v[48:51], v[92:95], 0
    v_mfma_f32_16x16x32_bf16 v[108:111], v[52:55], v[92:95], 0
    s_nop 7
    v_cndmask_b32 v104, v104, v108, s[42:43]
    v_cndmask_b32 v105, v105, v109, s[42:43]
    v_cndmask_b32 v106, v106, v110, s[42:43]
    v_cndmask_b32 v107, v107, v111, s[42:43]
    v_mul_f32 v104, v104, v81
    v_mul_f32 v105, v105, v81
    v_mul_f32 v106, v106, v81
    v_mul_f32 v107, v107, v81
    s_mov_b32 s7, 2000000
L_lw_9:
    ds_read_b32 v4, v2 offset:20
    s_waitcnt lgkmcnt(0)
    v_readfirstlane_b32 s6, v4
    s_cmp_ge_u32 s6, 4
    s_cbranch_scc1 L_ld_10
    s_sleep 1
    s_sub_u32 s7, s7, 1
    s_cmp_lg_u32 s7, 0
    s_cbranch_scc1 L_lw_9
L_ld_10:
    buffer_load_dwordx4 v[112:115], v65, s[52:55], s60 offen sc1
    buffer_load_dwordx4 v[96:99], v64, s[52:55], s58 offen sc1
    buffer_load_dwordx4 v[100:103], v64, s[52:55], s59 offen sc1
    s_mov_b32 s7, 2000000
L_lw_14:
    ds_read_b32 v4, v2 offset:8
    s_waitcnt lgkmcnt(0)
    v_readfirstlane_b32 s6, v4
    s_cmp_ge_u32 s6, 114
    s_cbranch_scc1 L_ld_15
    s_sub_u32 s7, s7, 1
    s_cmp_lg_u32 s7, 0
    s_cbranch_scc1 L_lw_14
L_ld_15:
    ds_read_b64_tr_b16 v[32:33], v69 offset:0
    ds_read_b64_tr_b16 v[34:35], v69 offset:1024
    ds_read_b64_tr_b16 v[36:37], v71 offset:0
    ds_read_b64_tr_b16 v[38:39], v71 offset:1024
    ds_read_b64_tr_b16 v[40:41], v69 offset:8192
    ds_read_b64_tr_b16 v[42:43], v69 offset:9216
    ds_read_b64_tr_b16 v[44:45], v71 offset:8192
    ds_read_b64_tr_b16 v[46:47], v71 offset:9216
    s_mov_b32 s7, 400000
    s_waitcnt vmcnt(0)
    v_cmpx_eq_u32 vcc, s36, v115
    v_cmpx_eq_u32 vcc, s36, v99
    v_cmpx_eq_u32 vcc, s36, v103
    s_nop 1
    s_cmp_eq_u64 exec, -1
    s_mov_b64 exec, -1
    s_cbranch_scc1 L_md_12
L_mp_11:
    s_cmp_gt_u32 s7, 399936
    s_cbranch_scc1 L_mn_13
    s_xor_b32 s60, s60, 0x400000
    s_xor_b32 s58, s58, 0x400000
    s_xor_b32 s59, s59, 0x400000
L_mn_13:
    s_mov_b32 s6, 0
    v_cmp_ne_u32 vcc, s36, v115
    s_nop 0
    s_mov_b64 exec, vcc
    s_cbranch_execz L_ms_16
    buffer_load_dwordx4 v[112:115], v65, s[52:55], s60 offen sc1
    s_mov_b32 s6, 1
L_ms_16:
    s_mov_b64 exec, -1
    v_cmp_ne_u32 vcc, s36, v99
    s_nop 0
    s_mov_b64 exec, vcc
    s_cbranch_execz L_ms_17
    buffer_load_dwordx4 v[96:99], v64, s[52:55], s58 offen sc1
    s_mov_b32 s6, 1
L_ms_17:
    s_mov_b64 exec, -1
    v_cmp_ne_u32 vcc, s36, v103
    s_nop 0
    s_mov_b64 exec, vcc
    s_cbranch_execz L_ms_18
    buffer_load_dwordx4 v[100:103], v64, s[52:55], s59 offen sc1
    s_mov_b32 s6, 1
L_ms_18:
    s_mov_b64 exec, -1
    s_cmp_eq_u32 s6, 0
    s_cbranch_scc1 L_md_12
    s_waitcnt vmcnt(0)
    s_sub_u32 s7, s7, 1
    s_cmp_lg_u32 s7, 0
    s_cbranch_scc1 L_mp_11
L_md_12:
    v_max_f32_dpp v116, v112, v112 quad_perm:[1,0,3,2] row_mask:0xf bank_mask:0xf
    v_lshlrev_b32 v24, 8, v96
    v_perm_b32 v25, v97, v96, s47
    v_max_f32_dpp v116, v116, v116 row_ror:8 row_mask:0xf bank_mask:0xf
    v_perm_b32 v26, v98, v97, s48
    v_mov_b32 v117, v116
    v_and_b32 v27, 0xffffff00, v98
    v_lshlrev_b32 v28, 8, v100
    v_permlane16_swap_b32 v116, v117
    v_max_f32 v116, v116, v117
    v_mov_b32 v117, v116
    v_perm_b32 v29, v101, v100, s47
    v_perm_b32 v30, v102, v101, s48
    v_permlane32_swap_b32 v116, v117
    v_max_f32 v116, v116, v117
    v_sub_f32 v116, v112, v116
    v_exp_f32 v116, v116
    v_and_b32 v31, 0xffffff00, v102
    v_mul_f32 v118, v116, v113
    v_mul_f32_dpp v24, v116, v24 quad_perm:[0,0,2,2] row_mask:0xf bank_mask:0xf
    v_mul_f32_dpp v25, v116, v25 quad_perm:[0,0,2,2] row_mask:0xf bank_mask:0xf
    v_mul_f32_dpp v26, v116, v26 quad_perm:[0,0,2,2] row_mask:0xf bank_mask:0xf
    v_mul_f32_dpp v27, v116, v27 quad_perm:[0,0,2,2] row_mask:0xf bank_mask:0xf
    v_add_f32_dpp v118, v118, v118 quad_perm:[1,0,3,2] row_mask:0xf bank_mask:0xf
    v_fmac_f32_dpp v24, v116, v28 quad_perm:[1,1,3,3] row_mask:0xf bank_mask:0xf
    v_fmac_f32_dpp v25, v116, v29 quad_perm:[1,1,3,3] row_mask:0xf bank_mask:0xf
    v_fmac_f32_dpp v26, v116, v30 quad_perm:[1,1,3,3] row_mask:0xf bank_mask:0xf
    v_fmac_f32_dpp v27, v116, v31 quad_perm:[1,1,3,3] row_mask:0xf bank_mask:0xf
    v_add_f32_dpp v118, v118, v118 row_ror:8 row_mask:0xf bank_mask:0xf
    v_permlane32_swap_b32 v24, v26
    v_permlane32_swap_b32 v25, v27
    v_mov_b32 v119, v118
    v_add_f32 v24, v24, v26
    v_add_f32 v25, v25, v27
    v_permlane16_swap_b32 v118, v119
    v_add_f32 v118, v118, v119
    v_permlane16_swap_b32 v24, v25
    v_mov_b32 v119, v118
    v_add_f32 v24, v24, v25
    s_nop 0
    v_permlane32_swap_b32 v118, v119
    v_add_f32_dpp v24, v24, v24 row_ror:8 row_mask:0xf bank_mask:0xf
    v_add_f32 v118, v118, v119
    v_rcp_f32 v118, v118
    s_mov_b64 exec, s[50:51]
    v_mul_f32 v24, v24, v118
    v_cvt_pk_bf16_f32 v24, v24, v24
    ds_write_b16 v66, v24 offset:128
    s_mov_b64 exec, 1
    ds_add_u32 v2, v3 offset:24
    s_mov_b64 exec, -1
    s_mov_b32 s7, 2000000
L_lw_19:
    ds_read_b32 v4, v2 offset:24
    ds_read_b128 v[84:87], v67 offset:128
    ds_read_b128 v[88:91], v67 offset:192
    s_waitcnt lgkmcnt(0)
    v_readfirstlane_b32 s6, v4
    s_cmp_ge_u32 s6, 4
    s_cbranch_scc1 L_ld_20
    s_sub_u32 s7, s7, 1
    s_cmp_lg_u32 s7, 0
    s_cbranch_scc1 L_lw_19
L_ld_20:
    v_mfma_f32_16x16x32_bf16 v[96:99], v[32:35], v[84:87], 0
    v_mfma_f32_16x16x32_bf16 v[100:103], v[36:39], v[84:87], 0
    v_mfma_f32_16x16x32_bf16 v[96:99], v[40:43], v[88:91], v[96:99]
    v_mfma_f32_16x16x32_bf16 v[100:103], v[44:47], v[88:91], v[100:103]
    s_nop 7
    v_cndmask_b32 v96, v96, v100, s[42:43]
    v_cndmask_b32 v97, v97, v101, s[42:43]
    v_cndmask_b32 v98, v98, v102, s[42:43]
    v_cndmask_b32 v99, v99, v103, s[42:43]
    v_fmac_f32 v104, v96, v80
    v_fmac_f32 v105, v97, v80
    v_fmac_f32 v106, v98, v80
    v_fmac_f32 v107, v99, v80
    v_perm_b32 v120, v105, v104, s44
    v_perm_b32 v121, v106, v105, s45
    v_perm_b32 v122, v107, v106, s46
    s_mov_b64 exec, s[40:41]
    buffer_store_dwordx4 v[120:123], v70, s[52:55], s61 offen sc1
    s_mov_b64 exec, 1
    ds_add_u32 v2, v3 offset:32
    s_mov_b64 exec, -1
    s_endpgm
L_kv:
    s_sub_u32 s37, s37, 5
    v_and_b32 v14, 3, v1
    v_mul_u32_u24 v14, 272, v14
    v_lshl_add_u32 v14, v6, 4, v14
    v_xor_b32 v12, v7, v6
    v_lshlrev_b32 v12, 4, v12
    v_lshl_add_u32 v120, v7, 8, v12
    s_lshl_b32 s4, s37, 13
    s_add_u32 s5, s4, 21504
    v_add_u32 v120, s5, v120
    v_xor_b32 v121, 64, v120
    v_xor_b32 v122, 128, v120
    v_xor_b32 v123, 192, v120
    v_bfe_u32 v13, v1, 2, 2
    v_lshlrev_b32 v13, 1, v13
    v_bfe_u32 v5, v1, 4, 1
    v_lshl_add_u32 v13, v5, 3, v13
    s_lshl_b32 s4, s37, 2
    v_bfe_u32 v5, v1, 1, 1
    v_add_u32 v5, s4, v5
    v_xor_b32 v13, v13, v5
    v_lshlrev_b32 v13, 4, v13
    s_mov_b32 s4, 54272
    v_bfe_u32 v12, v1, 4, 2
    v_lshlrev_b32 v12, 11, v12
    v_bfe_u32 v5, v1, 2, 2
    v_lshl_add_u32 v12, v5, 8, v12
    v_bfe_u32 v5, v1, 0, 1
    v_lshl_add_u32 v12, v5, 3, v12
    v_add_u32 v12, s4, v12
    v_add_u32 v12, v12, v13
    v_xor_b32 v13, 32, v12
    s_lshl_b32 s4, s37, 5
    v_bfe_u32 v8, v1, 0, 2
    v_lshlrev_b32 v8, 3, v8
    v_add_u32 v8, s4, v8
    v_bfe_u32 v9, v1, 0, 2
    v_lshlrev_b32 v9, 3, v9
    s_lshl_b32 s4, s37, 6
    v_bfe_u32 v10, v1, 3, 1
    v_lshlrev_b32 v10, 5, v10
    v_bfe_u32 v5, v1, 4, 2
    v_lshl_add_u32 v10, v5, 3, v10
    v_bfe_u32 v5, v1, 2, 1
    v_lshl_add_u32 v10, v5, 2, v10
    v_add_u32 v10, s4, v10
    v_and_b32 v5, 3, v1
    v_mul_u32_u24 v5, 272, v5
    v_add_u32 v10, v10, v5
    s_lshl_b32 s3, s38, 16
    s_lshl_b32 s4, s39, 11
    s_add_u32 s3, s3, s4
    s_lshl_b32 s4, s37, 7
    s_add_u32 s3, s3, s4
    s_lshl_b32 s4, s38, 12
    s_add_u32 s3, s3, s4
    s_lshl_b32 s4, s39, 7
    s_add_u32 s3, s3, s4
    s_add_u32 s3, s3, 0x80000
    v_bfe_u32 v11, v1, 0, 2
    v_lshlrev_b32 v11, 9, v11
    v_bfe_u32 v5, v1, 2, 1
    v_lshl_add_u32 v11, v5, 6, v11
    v_bfe_u32 v5, v1, 4, 2
    v_lshl_add_u32 v11, v5, 4, v11
    s_lshl_b32 s5, s38, 11
    s_lshr_b32 s4, s39, 4
    s_lshl_b32 s4, s4, 10
    s_add_u32 s5, s5, s4
    s_and_b32 s4, s39, 15
    s_lshl_b32 s4, s4, 4
    s_add_u32 s5, s5, s4
    s_add_u32 s5, s5, 0x60000
    v_bfe_u32 v124, v1, 0, 2
    v_lshlrev_b32 v124, 8, v124
    v_bfe_u32 v5, v1, 2, 1
    v_cmp_eq_u32 s[42:43], 1, v5
    v_bfe_u32 v5, v1, 3, 1
    v_cmp_eq_u32 s[58:59], 1, v5
    v_add_u32 v125, 0x700, v14
    v_mov_b32 v5, 0x1d400
    v_cndmask_b32 v126, v5, v125, s[42:43]
    v_cndmask_b32 v125, v125, v5, s[42:43]
    s_mov_b32 s50, 0x00ff00ff
    s_mov_b32 s51, 0x00ff00ff
    s_waitcnt lgkmcnt(0)
    s_mul_i32 s36, s36, 0x9E3779B1
    s_add_u32 s36, s36, 0x7F4A7C15
    v_mov_b32 v119, s36
    v_mov_b32 v115, s36
    s_lshl_b32 s40, s38, 14
    s_lshr_b32 s4, s39, 4
    s_lshl_b32 s4, s4, 13
    s_add_u32 s40, s40, s4
    s_lshl_b32 s4, s37, 11
    s_add_u32 s40, s40, s4
    s_add_u32 s40, s40, 0x10000
    s_mul_i32 s4, s37, 272
    v_lshlrev_b32 v62, 3, v1
    v_add_u32 v62, s4, v62
    v_lshlrev_b32 v15, 4, v1
    s_xor_b32 s41, s36, s49
    s_barrier
    s_mov_b32 s7, 2000000
L_lw_21:
    ds_read_b32 v4, v2 offset:8
    s_waitcnt lgkmcnt(0)
    v_readfirstlane_b32 s6, v4
    s_cmp_ge_u32 s6, 32
    s_cbranch_scc1 L_ld_22
    s_sleep 1
    s_sub_u32 s7, s7, 1
    s_cmp_lg_u32 s7, 0
    s_cbranch_scc1 L_lw_21
L_ld_22:
    buffer_load_dwordx4 v[128:131], v15, s[52:55], s40 offen sc1
    buffer_load_dwordx4 v[132:135], v15, s[52:55], s40 offen offset:1024 sc1
    s_mov_b32 s7, 2000000
L_lw_23:
    ds_read_b32 v4, v2 offset:8
    s_waitcnt lgkmcnt(0)
    v_readfirstlane_b32 s6, v4
    s_cmp_ge_u32 s6, 38
    s_cbranch_scc1 L_ld_24
    s_sleep 1
    s_sub_u32 s7, s7, 1
    s_cmp_lg_u32 s7, 0
    s_cbranch_scc1 L_lw_23
L_ld_24:
    buffer_load_dwordx4 v[136:139], v15, s[52:55], s40 offen sc1
    buffer_load_dwordx4 v[140:143], v15, s[52:55], s40 offen offset:1024 sc1
    s_mov_b32 s7, 2000000
L_lw_25:
    ds_read_b32 v4, v2 offset:8
    s_waitcnt lgkmcnt(0)
    v_readfirstlane_b32 s6, v4
    s_cmp_ge_u32 s6, 45
    s_cbranch_scc1 L_ld_26
    s_sleep 1
    s_sub_u32 s7, s7, 1
    s_cmp_lg_u32 s7, 0
    s_cbranch_scc1 L_lw_25
L_ld_26:
    buffer_load_dwordx4 v[144:147], v15, s[52:55], s40 offen sc1
    buffer_load_dwordx4 v[148:151], v15, s[52:55], s40 offen offset:1024 sc1
    s_waitcnt vmcnt(4)
    v_cmpx_eq_u32 vcc, s41, v131
    v_cmpx_eq_u32 vcc, s41, v135
    s_nop 1
    s_cmp_eq_u64 exec, -1
    s_mov_b64 exec, -1
    s_cbranch_scc0 L_qn_27
    v_lshlrev_b32 v36, 8, v128
    v_perm_b32 v37, v129, v128, s47
    v_perm_b32 v38, v130, v129, s48
    v_and_b32 v39, 0xffffff00, v130
    v_lshlrev_b32 v40, 8, v132
    v_perm_b32 v41, v133, v132, s47
    v_perm_b32 v42, v134, v133, s48
    v_and_b32 v43, 0xffffff00, v134
    s_branch L_qok
L_qn_27:
    s_mov_b32 s7, 2000000
L_lw_28:
    ds_read_b32 v4, v2 offset:8
    s_waitcnt lgkmcnt(0)
    v_readfirstlane_b32 s6, v4
    s_cmp_ge_u32 s6, 53
    s_cbranch_scc1 L_ld_29
    s_sleep 1
    s_sub_u32 s7, s7, 1
    s_cmp_lg_u32 s7, 0
    s_cbranch_scc1 L_lw_28
L_ld_29:
    buffer_load_dwordx4 v[152:155], v15, s[52:55], s40 offen sc1
    buffer_load_dwordx4 v[156:159], v15, s[52:55], s40 offen offset:1024 sc1
    s_waitcnt vmcnt(4)
    v_cmpx_eq_u32 vcc, s41, v139
    v_cmpx_eq_u32 vcc, s41, v143
    s_nop 1
    s_cmp_eq_u64 exec, -1
    s_mov_b64 exec, -1
    s_cbranch_scc0 L_qn_30
    v_lshlrev_b32 v36, 8, v136
    v_perm_b32 v37, v137, v136, s47
    v_perm_b32 v38, v138, v137, s48
    v_and_b32 v39, 0xffffff00, v138
    v_lshlrev_b32 v40, 8, v140
    v_perm_b32 v41, v141, v140, s47
    v_perm_b32 v42, v142, v141, s48
    v_and_b32 v43, 0xffffff00, v142
    s_branch L_qok
L_qn_30:
    s_waitcnt vmcnt(2)
    v_cmpx_eq_u32 vcc, s41, v147
    v_cmpx_eq_u32 vcc, s41, v151
    s_nop 1
    s_cmp_eq_u64 exec, -1
    s_mov_b64 exec, -1
    s_cbranch_scc0 L_qn_31
    v_lshlrev_b32 v36, 8, v144
    v_perm_b32 v37, v145, v144, s47
    v_perm_b32 v38, v146, v145, s48
    v_and_b32 v39, 0xffffff00, v146
    v_lshlrev_b32 v40, 8, v148
    v_perm_b32 v41, v149, v148, s47
    v_perm_b32 v42, v150, v149, s48
    v_and_b32 v43, 0xffffff00, v150
    s_branch L_qok
L_qn_31:
    s_mov_b32 s7, 400000
    s_waitcnt vmcnt(0)
    v_cmpx_eq_u32 vcc, s41, v155
    v_cmpx_eq_u32 vcc, s41, v159
    s_nop 1
    s_cmp_eq_u64 exec, -1
    s_mov_b64 exec, -1
    s_cbranch_scc1 L_md_33
L_mp_32:
    s_cmp_gt_u32 s7, 399936
    s_cbranch_scc1 L_mn_34
    s_xor_b32 s40, s40, 0x400000
L_mn_34:
    s_mov_b32 s6, 0
    v_xor_b32 v5, s36, v155
    v_cmp_lt_u32 vcc, 15, v5
    s_nop 0
    s_mov_b64 exec, vcc
    s_cbranch_execz L_ms_35
    buffer_load_dwordx4 v[152:155], v15, s[52:55], s40 offen sc1
    s_mov_b32 s6, 1
L_ms_35:
    s_mov_b64 exec, -1
    v_xor_b32 v5, s36, v159
    v_cmp_lt_u32 vcc, 15, v5
    s_nop 0
    s_mov_b64 exec, vcc
    s_cbranch_execz L_ms_36
    buffer_load_dwordx4 v[156:159], v15, s[52:55], s40 offen offset:1024 sc1
    s_mov_b32 s6, 1
L_ms_36:
    s_mov_b64 exec, -1
    s_cmp_eq_u32 s6, 0
    s_cbranch_scc1 L_md_33
    s_waitcnt vmcnt(0)
    s_sub_u32 s7, s7, 1
    s_cmp_lg_u32 s7, 0
    s_cbranch_scc1 L_mp_32
L_md_33:
    v_cmpx_eq_u32 vcc, s41, v155
    v_cmpx_eq_u32 vcc, s41, v159
    s_nop 1
    s_cmp_eq_u64 exec, -1
    s_mov_b64 exec, -1
    s_cbranch_scc1 L_qloc
    s_mov_b64 exec, 1
    ds_add_u32 v2, v3 offset:4
    s_mov_b64 exec, -1
L_qloc:
    v_lshlrev_b32 v36, 8, v152
    v_perm_b32 v37, v153, v152, s47
    v_perm_b32 v38, v154, v153, s48
    v_and_b32 v39, 0xffffff00, v154
    v_lshlrev_b32 v40, 8, v156
    v_perm_b32 v41, v157, v156, s47
    v_perm_b32 v42, v158, v157, s48
    v_and_b32 v43, 0xffffff00, v158
L_qok:
    v_add_f32 v36, v36, v40
    v_add_f32 v37, v37, v41
    v_add_f32 v38, v38, v42
    v_add_f32 v39, v39, v43
    v_mov_b32 v40, v36
    v_mov_b32 v41, v37
    v_mov_b32 v42, v38
    v_mov_b32 v43, v39
    v_permlane32_swap_b32 v36, v40
    v_permlane32_swap_b32 v37, v41
    v_permlane32_swap_b32 v38, v42
    v_permlane32_swap_b32 v39, v43
    v_add_f32 v36, v36, v40
    v_add_f32 v37, v37, v41
    v_add_f32 v38, v38, v42
    v_add_f32 v39, v39, v43
    v_cvt_pk_bf16_f32 v36, v36, v37
    v_cvt_pk_bf16_f32 v37, v38, v39
    s_mov_b64 exec, 0xffffffff
    ds_write_b64 v62, v[36:37] offset:512
    s_mov_b64 exec, 1
    ds_add_u32 v2, v3 offset:0
    s_mov_b64 exec, -1
    s_mov_b32 s7, 2000000
L_lw_37:
    ds_read_b32 v4, v2 offset:8
    s_waitcnt lgkmcnt(0)
    v_readfirstlane_b32 s6, v4
    s_cmp_ge_u32 s6, 58
    s_cbranch_scc1 L_ld_38
    s_sleep 1
    s_sub_u32 s7, s7, 1
    s_cmp_lg_u32 s7, 0
    s_cbranch_scc1 L_lw_37
L_ld_38:
    ds_read_b128 v[16:19], v120 offset:0
    ds_read_b128 v[20:23], v121 offset:0
    ds_read_b128 v[24:27], v122 offset:0
    ds_read_b128 v[28:31], v123 offset:0
    ds_read_b128 v[32:35], v120 offset:4096
    ds_read_b128 v[36:39], v121 offset:4096
    ds_read_b128 v[40:43], v122 offset:4096
    ds_read_b128 v[44:47], v123 offset:4096
    s_mov_b32 s7, 2000000
L_lw_39:
    ds_read_b32 v4, v2 offset:0
    ds_read_b128 v[80:83], v14 offset:512
    ds_read_b128 v[84:87], v14 offset:576
    ds_read_b128 v[88:91], v14 offset:640
    ds_read_b128 v[92:95], v14 offset:704
    ds_read_b32 v5, v2 offset:4
    ds_read_b32 v127, v2 offset:8
    s_waitcnt lgkmcnt(0)
    v_readfirstlane_b32 s6, v4
    s_cmp_ge_u32 s6, 4
    s_cbranch_scc1 L_ld_40
    s_sleep 1
    s_sub_u32 s7, s7, 1
    s_cmp_lg_u32 s7, 0
    s_cbranch_scc1 L_lw_39
L_ld_40:
    v_readfirstlane_b32 s62, v127
    v_mfma_f32_16x16x32_bf16 v[96:99], v[16:19], v[80:83], 0
    v_mfma_f32_16x16x32_bf16 v[100:103], v[32:35], v[80:83], 0
    v_mfma_f32_16x16x32_bf16 v[96:99], v[20:23], v[84:87], v[96:99]
    v_mfma_f32_16x16x32_bf16 v[100:103], v[36:39], v[84:87], v[100:103]
    v_mfma_f32_16x16x32_bf16 v[96:99], v[24:27], v[88:91], v[96:99]
    v_mfma_f32_16x16x32_bf16 v[100:103], v[40:43], v[88:91], v[100:103]
    v_mfma_f32_16x16x32_bf16 v[96:99], v[28:31], v[92:95], v[96:99]
    v_mfma_f32_16x16x32_bf16 v[100:103], v[44:47], v[92:95], v[100:103]
    v_readfirstlane_b32 s63, v5
    s_cmp_ge_u32 s62, 98
    s_cbranch_scc0 L_nospec
    ds_read_b64_tr_b16 v[16:17], v12 offset:0
    ds_read_b64_tr_b16 v[18:19], v12 offset:1024
    ds_read_b64_tr_b16 v[20:21], v13 offset:0
    ds_read_b64_tr_b16 v[22:23], v13 offset:1024
    ds_read_b64_tr_b16 v[24:25], v12 offset:8192
    ds_read_b64_tr_b16 v[26:27], v12 offset:9216
    ds_read_b64_tr_b16 v[28:29], v13 offset:8192
    ds_read_b64_tr_b16 v[30:31], v13 offset:9216
    ds_read_b64_tr_b16 v[32:33], v12 offset:16384
    ds_read_b64_tr_b16 v[34:35], v12 offset:17408
    ds_read_b64_tr_b16 v[36:37], v13 offset:16384
    ds_read_b64_tr_b16 v[38:39], v13 offset:17408
    ds_read_b64_tr_b16 v[40:41], v12 offset:24576
    ds_read_b64_tr_b16 v[42:43], v12 offset:25600
    ds_read_b64_tr_b16 v[44:45], v13 offset:24576
    ds_read_b64_tr_b16 v[46:47], v13 offset:25600
L_nospec:
    s_nop 4
    s_mov_b32 s4, 0x3db504f3
    v_cvt_pk_bf16_f32 v108, v96, v97
    v_cvt_pk_bf16_f32 v109, v98, v99
    v_cvt_pk_bf16_f32 v110, v100, v101
    v_cvt_pk_bf16_f32 v111, v102, v103
    v_cndmask_b32 v108, v108, v109, s[42:43]
    v_cndmask_b32 v110, v110, v111, s[42:43]
    v_cndmask_b32 v108, v108, v110, s[58:59]
    v_lshlrev_b32 v106, 16, v108
    v_and_b32 v107, 0xffff0000, v108
    v_mul_f32 v106, s4, v106
    v_mul_f32 v107, s4, v107
    v_cvt_pk_bf16_f32 v108, v106, v107
    v_lshlrev_b32 v106, 16, v108
    v_and_b32 v107, 0xffff0000, v108
    v_max_f32 v104, v106, v107
    s_mov_b32 s4, 0x3fb8aa3b
    s_nop 0
    v_max_f32_dpp v104, v104, v104 row_ror:4 row_mask:0xf bank_mask:0xf
    s_nop 1
    v_max_f32_dpp v104, v104, v104 row_ror:8 row_mask:0xf bank_mask:0xf
    v_mov_b32 v105, v104
    s_nop 1
    v_permlane16_swap_b32 v104, v105
    v_max_f32 v104, v104, v105
    v_mov_b32 v105, v104
    s_nop 1
    v_permlane32_swap_b32 v104, v105
    v_max_f32 v104, v104, v105
    v_mul_f32 v104, s4, v104
    v_fma_f32 v106, v106, s4, -v104
    v_fma_f32 v107, v107, s4, -v104
    v_exp_f32 v106, v106
    v_exp_f32 v107, v107
    s_nop 0
    v_add_f32 v105, v106, v107
    v_cvt_pk_bf16_f32 v108, v106, v107
    ds_write_b32 v10, v108 offset:1792
    v_add_f32_dpp v105, v105, v105 row_ror:4 row_mask:0xf bank_mask:0xf
    s_nop 1
    v_add_f32_dpp v105, v105, v105 row_ror:8 row_mask:0xf bank_mask:0xf
    v_mov_b32 v106, v105
    s_nop 1
    v_permlane16_swap_b32 v105, v106
    v_add_f32 v105, v105, v106
    v_mov_b32 v106, v105
    s_nop 1
    v_permlane32_swap_b32 v105, v106
    v_add_f32 v105, v105, v106
    s_mov_b64 exec, 0xf
    ds_write_b64 v8, v[104:105] offset:1664
    s_mov_b64 exec, 1
    ds_add_u32 v2, v3 offset:16
    s_mov_b64 exec, -1
    s_mov_b32 s7, 2000000
L_lw_41:
    ds_read_b32 v4, v2 offset:16
    ds_read_b64 v[96:97], v9 offset:1664
    ds_read_b64 v[98:99], v9 offset:1696
    ds_read_b64 v[100:101], v9 offset:1728
    ds_read_b64 v[102:103], v9 offset:1760
    ds_read_b128 v[48:51], v125 offset:0
    ds_read_b128 v[64:67], v126 offset:0
    ds_read_b128 v[52:55], v125 offset:64
    ds_read_b128 v[68:71], v126 offset:64
    ds_read_b128 v[56:59], v125 offset:128
    ds_read_b128 v[72:75], v126 offset:128
    ds_read_b128 v[60:63], v125 offset:192
    ds_read_b128 v[76:79], v126 offset:192
    s_waitcnt lgkmcnt(0)
    v_readfirstlane_b32 s6, v4
    s_cmp_ge_u32 s6, 4
    s_cbranch_scc1 L_ld_42
    s_sub_u32 s7, s7, 1
    s_cmp_lg_u32 s7, 0
    s_cbranch_scc1 L_lw_41
L_ld_42:
    s_cmp_ge_u32 s62, 98
    s_cbranch_scc0 L_vslow
    v_mfma_f32_16x16x32_bf16 v[80:83], v[16:19], v[48:51], 0
    v_mfma_f32_16x16x32_bf16 v[80:83], v[20:23], v[64:67], v[80:83]
    v_mfma_f32_16x16x32_bf16 v[84:87], v[24:27], v[52:55], 0
    v_mfma_f32_16x16x32_bf16 v[84:87], v[28:31], v[68:71], v[84:87]
    v_mfma_f32_16x16x32_bf16 v[88:91], v[32:35], v[56:59], 0
    v_mfma_f32_16x16x32_bf16 v[88:91], v[36:39], v[72:75], v[88:91]
    v_mfma_f32_16x16x32_bf16 v[92:95], v[40:43], v[60:63], 0
    v_mfma_f32_16x16x32_bf16 v[92:95], v[44:47], v[76:79], v[92:95]
    v_max3_f32 v112, v96, v98, v100
    v_max_f32 v112, v112, v102
    v_sub_f32 v104, v96, v112
    v_sub_f32 v105, v98, v112
    v_sub_f32 v106, v100, v112
    v_sub_f32 v107, v102, v112
    v_exp_f32 v104, v104
    v_exp_f32 v105, v105
    v_exp_f32 v106, v106
    v_exp_f32 v107, v107
    s_cmp_lg_u32 s37, 0
    s_cbranch_scc1 L_noml1
    v_mul_f32 v113, v104, v97
    v_fmac_f32 v113, v105, v99
    v_fmac_f32 v113, v106, v101
    v_fmac_f32 v113, v107, v103
    s_mov_b64 exec, 0xf
    buffer_store_dwordx4 v[112:115], v124, s[52:55], s5 offen
    s_cmp_eq_u32 s63, 0
    s_cbranch_scc1 L_noml1
    s_xor_b32 s5, s5, 0x400000
    buffer_store_dwordx4 v[112:115], v124, s[52:55], s5 offen sc1
L_noml1:
    s_mov_b64 exec, -1
    v_pk_mul_f32 v[108:109], v[80:81], v[104:105] op_sel_hi:[1,0]
    v_pk_mul_f32 v[110:111], v[82:83], v[104:105] op_sel_hi:[1,0]
    v_pk_fma_f32 v[108:109], v[84:85], v[104:105], v[108:109] op_sel:[0,1,0] op_sel_hi:[1,1,1]
    v_pk_fma_f32 v[110:111], v[86:87], v[104:105], v[110:111] op_sel:[0,1,0] op_sel_hi:[1,1,1]
    v_pk_fma_f32 v[108:109], v[88:89], v[106:107], v[108:109] op_sel_hi:[1,0,1]
    v_pk_fma_f32 v[110:111], v[90:91], v[106:107], v[110:111] op_sel_hi:[1,0,1]
    v_pk_fma_f32 v[108:109], v[92:93], v[106:107], v[108:109] op_sel:[0,1,0] op_sel_hi:[1,1,1]
    v_pk_fma_f32 v[110:111], v[94:95], v[106:107], v[110:111] op_sel:[0,1,0] op_sel_hi:[1,1,1]
    s_branch L_vdone
L_vslow:
    v_max3_f32 v112, v96, v98, v100
    v_max_f32 v112, v112, v102
    v_sub_f32 v104, v96, v112
    v_sub_f32 v105, v98, v112
    v_sub_f32 v106, v100, v112
    v_sub_f32 v107, v102, v112
    v_exp_f32 v104, v104
    v_exp_f32 v105, v105
    v_exp_f32 v106, v106
    v_exp_f32 v107, v107
    s_cmp_lg_u32 s37, 0
    s_cbranch_scc1 L_noml2
    v_mul_f32 v113, v104, v97
    v_fmac_f32 v113, v105, v99
    v_fmac_f32 v113, v106, v101
    v_fmac_f32 v113, v107, v103
    s_mov_b64 exec, 0xf
    buffer_store_dwordx4 v[112:115], v124, s[52:55], s5 offen
    s_cmp_eq_u32 s63, 0
    s_cbranch_scc1 L_noml2
    s_xor_b32 s5, s5, 0x400000
    buffer_store_dwordx4 v[112:115], v124, s[52:55], s5 offen sc1
L_noml2:
    s_mov_b64 exec, -1
    s_mov_b32 s7, 2000000
L_lw_43:
    ds_read_b32 v4, v2 offset:8
    s_waitcnt lgkmcnt(0)
    v_readfirstlane_b32 s6, v4
    s_cmp_ge_u32 s6, 90
    s_cbranch_scc1 L_ld_44
    s_sleep 1
    s_sub_u32 s7, s7, 1
    s_cmp_lg_u32 s7, 0
    s_cbranch_scc1 L_lw_43
L_ld_44:
    ds_read_b64_tr_b16 v[16:17], v12 offset:0
    ds_read_b64_tr_b16 v[18:19], v12 offset:1024
    ds_read_b64_tr_b16 v[20:21], v13 offset:0
    ds_read_b64_tr_b16 v[22:23], v13 offset:1024
    ds_read_b64_tr_b16 v[24:25], v12 offset:8192
    ds_read_b64_tr_b16 v[26:27], v12 offset:9216
    ds_read_b64_tr_b16 v[28:29], v13 offset:8192
    ds_read_b64_tr_b16 v[30:31], v13 offset:9216
    ds_read_b64_tr_b16 v[32:33], v12 offset:16384
    ds_read_b64_tr_b16 v[34:35], v12 offset:17408
    ds_read_b64_tr_b16 v[36:37], v13 offset:16384
    ds_read_b64_tr_b16 v[38:39], v13 offset:17408
    s_waitcnt lgkmcnt(8)
    v_mfma_f32_16x16x32_bf16 v[80:83], v[16:19], v[48:51], 0
    v_mfma_f32_16x16x32_bf16 v[80:83], v[20:23], v[64:67], v[80:83]
    s_waitcnt lgkmcnt(4)
    v_mfma_f32_16x16x32_bf16 v[84:87], v[24:27], v[52:55], 0
    v_mfma_f32_16x16x32_bf16 v[84:87], v[28:31], v[68:71], v[84:87]
    s_waitcnt lgkmcnt(0)
    v_mfma_f32_16x16x32_bf16 v[88:91], v[32:35], v[56:59], 0
    v_mfma_f32_16x16x32_bf16 v[88:91], v[36:39], v[72:75], v[88:91]
    s_nop 5
    v_pk_mul_f32 v[108:109], v[80:81], v[104:105] op_sel_hi:[1,0]
    v_pk_mul_f32 v[110:111], v[82:83], v[104:105] op_sel_hi:[1,0]
    v_pk_fma_f32 v[108:109], v[84:85], v[104:105], v[108:109] op_sel:[0,1,0] op_sel_hi:[1,1,1]
    v_pk_fma_f32 v[110:111], v[86:87], v[104:105], v[110:111] op_sel:[0,1,0] op_sel_hi:[1,1,1]
    v_pk_fma_f32 v[108:109], v[88:89], v[106:107], v[108:109] op_sel_hi:[1,0,1]
    v_pk_fma_f32 v[110:111], v[90:91], v[106:107], v[110:111] op_sel_hi:[1,0,1]
    s_mov_b32 s7, 2000000
L_lw_45:
    ds_read_b32 v4, v2 offset:8
    ds_read_b64_tr_b16 v[40:41], v12 offset:24576
    ds_read_b64_tr_b16 v[42:43], v12 offset:25600
    ds_read_b64_tr_b16 v[44:45], v13 offset:24576
    ds_read_b64_tr_b16 v[46:47], v13 offset:25600
    s_waitcnt lgkmcnt(0)
    v_readfirstlane_b32 s6, v4
    s_cmp_ge_u32 s6, 98
    s_cbranch_scc1 L_ld_46
    s_sub_u32 s7, s7, 1
    s_cmp_lg_u32 s7, 0
    s_cbranch_scc1 L_lw_45
L_ld_46:
    v_mfma_f32_16x16x32_bf16 v[92:95], v[40:43], v[60:63], 0
    v_mfma_f32_16x16x32_bf16 v[92:95], v[44:47], v[76:79], v[92:95]
    s_nop 7
    v_pk_fma_f32 v[108:109], v[92:93], v[106:107], v[108:109] op_sel:[0,1,0] op_sel_hi:[1,1,1]
    v_pk_fma_f32 v[110:111], v[94:95], v[106:107], v[110:111] op_sel:[0,1,0] op_sel_hi:[1,1,1]
L_vdone:
    v_perm_b32 v116, v109, v108, s44
    v_perm_b32 v117, v110, v109, s45
    v_perm_b32 v118, v111, v110, s46
    s_mov_b64 exec, s[50:51]
    buffer_store_dwordx4 v[116:119], v11, s[52:55], s3 offen
    s_cmp_eq_u32 s63, 0
    s_cbranch_scc1 L_oploc
    s_xor_b32 s3, s3, 0x400000
    buffer_store_dwordx4 v[116:119], v11, s[52:55], s3 offen sc1
L_oploc:
    s_mov_b64 exec, 1
    ds_add_u32 v2, v3 offset:20
    s_mov_b64 exec, -1
    s_endpgm
L_rrole:
    s_mov_b32 s52, s34
    s_mov_b32 s53, s35
    s_mov_b32 s54, 16777216
    s_mov_b32 s55, 0x20000
    s_lshl_b32 s3, s38, 14
    s_bfe_u32 s4, s39, 0x20001
    s_lshl_b32 s4, s4, 11
    s_add_u32 s3, s3, s4
    s_lshr_b32 s4, s39, 3
    s_lshl_b32 s4, s4, 9
    s_add_u32 s3, s3, s4
    s_and_b32 s4, s39, 1
    s_lshl_b32 s4, s4, 8
    s_add_u32 s3, s3, s4
    s_add_u32 s3, s3, 0x10000
    v_bfe_u32 v16, v1, 1, 1
    v_lshlrev_b32 v16, 13, v16
    v_bfe_u32 v5, v1, 0, 1
    v_lshl_add_u32 v16, v5, 7, v16
    s_mov_b64 exec, 0xf
    buffer_load_dword v59, v16, s[52:55], s3 offen sc1
    s_mov_b64 exec, -1
    s_lshl_b32 s3, s38, 14
    s_and_b32 s4, s39, 7
    s_lshl_b32 s4, s4, 11
    s_add_u32 s3, s3, s4
    s_lshr_b32 s4, s39, 3
    s_lshl_b32 s4, s4, 8
    s_add_u32 s3, s3, s4
    s_lshl_b32 s4, s38, 10
    s_add_u32 s3, s3, s4
    s_and_b32 s4, s39, 7
    s_lshl_b32 s4, s4, 7
    s_add_u32 s3, s3, s4
    s_add_u32 s3, s3, 0x30000
    v_bfe_u32 v16, v1, 1, 1
    v_lshlrev_b32 v16, 10, v16
    v_bfe_u32 v5, v1, 0, 1
    v_lshl_add_u32 v16, v5, 7, v16
    s_mov_b64 exec, 0xf
    buffer_load_dword v58, v16, s[52:55], s3 offen sc1
    s_mov_b64 exec, -1
    s_mov_b32 s48, s28
    s_mov_b32 s49, s29
    s_mov_b32 s50, 1024
    s_mov_b32 s51, 0x20000
    s_mov_b32 s56, s30
    s_mov_b32 s57, s31
    s_mov_b32 s58, 2048
    s_mov_b32 s59, 0x20000
    s_mov_b32 s40, s22
    s_mov_b32 s41, s23
    s_mov_b32 s42, 3584
    s_mov_b32 s43, 0x20000
    s_mov_b32 s44, s26
    s_mov_b32 s45, s27
    s_mov_b32 s46, 1024
    s_mov_b32 s47, 0x20000
    v_lshlrev_b32 v15, 4, v1
    buffer_load_dwordx4 v[72:75], v15, s[48:51], 0 offen
    s_lshl_b32 s60, s38, 5
    s_and_b32 s4, s39, 3
    s_lshl_b32 s4, s4, 3
    s_add_u32 s60, s60, s4
    s_lshr_b32 s4, s39, 2
    s_add_u32 s60, s60, s4
    s_and_b32 s61, s60, 1
    s_lshr_b32 s33, s60, 4
    s_lshl_b32 s33, s33, 5
    s_bfe_u32 s4, s60, 0x10001
    s_lshl_b32 s4, s4, 4
    s_add_u32 s33, s33, s4
    s_bfe_u32 s4, s60, 0x20002
    s_lshl_b32 s4, s4, 2
    s_add_u32 s33, s33, s4
    v_lshlrev_b32 v19, 1, v6
    s_lshl_b32 s4, s33, 1
    buffer_load_ushort v76, v19, s[44:47], s4 offen
    s_mul_i32 s3, s38, 224
    s_lshr_b32 s4, s39, 2
    s_mul_i32 s5, s4, 28
    s_add_u32 s3, s3, s5
    s_lshl_b32 s3, s3, 1
    v_bfe_u32 v22, v1, 0, 3
    v_lshlrev_b32 v22, 3, v22
    v_bfe_u32 v5, v1, 4, 2
    v_lshl_add_u32 v22, v5, 1, v22
    buffer_load_ushort v77, v22, s[40:43], s3 offen
    v_and_b32 v21, 7, v1
    v_cmp_gt_u32 s[42:43], 7, v21
    v_min_u32 v21, 6, v21
    v_bfe_u32 v78, v1, 4, 2
    v_lshlrev_b32 v78, 11, v78
    v_bfe_u32 v5, v1, 4, 2
    v_lshl_add_u32 v78, v5, 7, v78
    v_bfe_u32 v5, v1, 3, 1
    v_lshl_add_u32 v78, v5, 10, v78
    v_lshl_add_u32 v78, v21, 4, v78
    s_lshl_b32 s62, s5, 2
    s_and_b32 s4, s38, 1
    s_lshl_b32 s4, s4, 7
    s_add_u32 s62, s62, s4
    s_lshl_b32 s4, s38, 14
    s_add_u32 s62, s62, s4
    s_lshl_b32 s4, s38, 10
    s_add_u32 s62, s62, s4
    s_add_u32 s62, s62, 0x30000
    s_add_u32 s32, s62, 8704
    v_bfe_u32 v79, v1, 3, 1
    v_lshlrev_b32 v79, 6, v79
    v_bfe_u32 v5, v1, 0, 3
    v_lshl_add_u32 v79, v5, 3, v79
    v_bfe_u32 v5, v1, 4, 2
    v_lshl_add_u32 v79, v5, 1, v79
    s_waitcnt lgkmcnt(0)
    s_mul_i32 s36, s36, 0x9E3779B1
    s_add_u32 s36, s36, 0x7F4A7C15
    s_mov_b32 s44, 0x05030201
    s_mov_b32 s45, 0x06050302
    s_mov_b32 s46, 0x07060503
    s_mov_b32 s47, 0x0504030c
    s_mov_b32 s48, 0x0403020c
    s_barrier
    ds_read_b128 v[64:67], v15 offset:3072
    ds_read_b128 v[68:71], v15 offset:4096
    s_lshl_b32 s3, s38, 11
    s_lshr_b32 s4, s39, 4
    s_lshl_b32 s4, s4, 10
    s_add_u32 s3, s3, s4
    s_bfe_u32 s4, s39, 0x10003
    s_lshl_b32 s4, s4, 7
    s_add_u32 s3, s3, s4
    s_add_u32 s3, s3, 0x60000
    v_lshlrev_b32 v16, 8, v1
    s_mov_b64 exec, 0xf
    buffer_load_dword v59, v16, s[52:55], s3 offen sc1
    s_mov_b64 exec, -1
    s_lshl_b32 s3, s38, 16
    s_lshl_b32 s4, s39, 11
    s_add_u32 s3, s3, s4
    s_lshl_b32 s4, s38, 12
    s_add_u32 s3, s3, s4
    s_lshl_b32 s4, s39, 7
    s_add_u32 s3, s3, s4
    s_add_u32 s3, s3, 0x80000
    v_lshlrev_b32 v16, 7, v1
    s_mov_b64 exec, 0xffff
    buffer_load_dword v58, v16, s[52:55], s3 offen sc1
    s_mov_b64 exec, -1
    s_waitcnt vmcnt(2) lgkmcnt(0)
    v_lshlrev_b32 v84, 16, v72
    v_and_b32 v85, 0xffff0000, v72
    v_lshlrev_b32 v86, 16, v73
    v_and_b32 v87, 0xffff0000, v73
    v_lshlrev_b32 v88, 16, v74
    v_and_b32 v89, 0xffff0000, v74
    v_lshlrev_b32 v90, 16, v75
    v_and_b32 v91, 0xffff0000, v75
    v_lshlrev_b32 v92, 16, v64
    v_and_b32 v93, 0xffff0000, v64
    v_lshlrev_b32 v94, 16, v65
    v_and_b32 v95, 0xffff0000, v65
    v_lshlrev_b32 v96, 16, v66
    v_and_b32 v97, 0xffff0000, v66
    v_lshlrev_b32 v98, 16, v67
    v_and_b32 v99, 0xffff0000, v67
    v_mul_f32 v92, v92, v84
    v_mul_f32 v93, v93, v85
    v_mul_f32 v94, v94, v86
    v_mul_f32 v95, v95, v87
    v_mul_f32 v96, v96, v88
    v_mul_f32 v97, v97, v89
    v_mul_f32 v98, v98, v90
    v_mul_f32 v99, v99, v91
    v_cvt_pk_bf16_f32 v100, v92, v93
    v_cvt_pk_bf16_f32 v101, v94, v95
    v_cvt_pk_bf16_f32 v102, v96, v97
    v_cvt_pk_bf16_f32 v103, v98, v99
    v_lshlrev_b32 v92, 16, v100
    v_and_b32 v93, 0xffff0000, v100
    v_lshlrev_b32 v94, 16, v101
    v_and_b32 v95, 0xffff0000, v101
    v_lshlrev_b32 v96, 16, v102
    v_and_b32 v97, 0xffff0000, v102
    v_lshlrev_b32 v98, 16, v103
    v_and_b32 v99, 0xffff0000, v103
    v_add_f32 v92, v92, v93
    v_add_f32 v94, v94, v95
    v_add_f32 v96, v96, v97
    v_add_f32 v98, v98, v99
    v_add_f32 v92, v92, v94
    v_add_f32 v96, v96, v98
    v_add_f32 v104, v92, v96
    v_lshlrev_b32 v92, 16, v68
    v_and_b32 v93, 0xffff0000, v68
    v_lshlrev_b32 v94, 16, v69
    v_and_b32 v95, 0xffff0000, v69
    v_lshlrev_b32 v96, 16, v70
    v_and_b32 v97, 0xffff0000, v70
    v_lshlrev_b32 v98, 16, v71
    v_and_b32 v99, 0xffff0000, v71
    v_mul_f32 v92, v92, v84
    v_mul_f32 v93, v93, v85
    v_mul_f32 v94, v94, v86
    v_mul_f32 v95, v95, v87
    v_mul_f32 v96, v96, v88
    v_mul_f32 v97, v97, v89
    v_mul_f32 v98, v98, v90
    v_mul_f32 v99, v99, v91
    v_cvt_pk_bf16_f32 v100, v92, v93
    v_cvt_pk_bf16_f32 v101, v94, v95
    v_cvt_pk_bf16_f32 v102, v96, v97
    v_cvt_pk_bf16_f32 v103, v98, v99
    v_lshlrev_b32 v92, 16, v100
    v_and_b32 v93, 0xffff0000, v100
    v_lshlrev_b32 v94, 16, v101
    v_and_b32 v95, 0xffff0000, v101
    v_lshlrev_b32 v96, 16, v102
    v_and_b32 v97, 0xffff0000, v102
    v_lshlrev_b32 v98, 16, v103
    v_and_b32 v99, 0xffff0000, v103
    v_add_f32 v92, v92, v93
    v_add_f32 v94, v94, v95
    v_add_f32 v96, v96, v97
    v_add_f32 v98, v98, v99
    v_add_f32 v92, v92, v94
    v_add_f32 v96, v96, v98
    v_add_f32 v105, v92, v96
    s_nop 0
    s_nop 0
    v_add_f32_dpp v104, v104, v104 quad_perm:[1,0,3,2] row_mask:0xf bank_mask:0xf
    v_add_f32_dpp v105, v105, v105 quad_perm:[1,0,3,2] row_mask:0xf bank_mask:0xf
    s_nop 0
    v_add_f32_dpp v104, v104, v104 quad_perm:[2,3,0,1] row_mask:0xf bank_mask:0xf
    v_add_f32_dpp v105, v105, v105 quad_perm:[2,3,0,1] row_mask:0xf bank_mask:0xf
    s_nop 0
    v_add_f32_dpp v104, v104, v104 row_half_mirror row_mask:0xf bank_mask:0xf
    v_add_f32_dpp v105, v105, v105 row_half_mirror row_mask:0xf bank_mask:0xf
    s_nop 0
    v_add_f32_dpp v104, v104, v104 row_mirror row_mask:0xf bank_mask:0xf
    v_add_f32_dpp v105, v105, v105 row_mirror row_mask:0xf bank_mask:0xf
    v_mov_b32 v106, v104
    v_mov_b32 v107, v105
    s_nop 0
    v_permlane16_swap_b32 v104, v106
    v_permlane16_swap_b32 v105, v107
    v_add_f32 v104, v104, v106
    v_add_f32 v105, v105, v107
    v_mov_b32 v106, v104
    v_mov_b32 v107, v105
    s_nop 0
    v_permlane32_swap_b32 v104, v106
    v_permlane32_swap_b32 v105, v107
    v_add_f32 v104, v104, v106
    v_add_f32 v105, v105, v107
    v_and_b32 v18, 1, v1
    v_cmp_eq_u32 vcc, 1, v18
    s_nop 1
    v_cndmask_b32 v104, v104, v105, vcc
    v_cvt_pk_bf16_f32 v104, v104, v104
    v_and_b32 v104, 0xffff0000, v104
    v_mul_f32 v104, 0xbfb8aa3b, v104
    v_exp_f32 v104, v104
    s_nop 0
    v_add_f32 v104, 1.0, v104
    v_rcp_f32 v104, v104
    s_nop 0
    v_cvt_pk_bf16_f32 v104, v104, v104
    v_and_b32 v80, 0xffff0000, v104
    v_sub_f32 v81, 1.0, v80
    v_cvt_pk_bf16_f32 v81, v81, v81
    v_and_b32 v81, 0xffff0000, v81
    s_mov_b64 exec, 3
    ds_write_b32 v8, v80 offset:64
    ds_write_b32 v8, v81 offset:72
    s_mov_b64 exec, -1
    v_readlane_b32 s5, v81, s61
    v_lshlrev_b32 v82, 16, v76
    v_lshlrev_b32 v62, 16, v77
    v_mul_f32 v82, s5, v82
    s_lshl_b32 s3, s60, 4
    s_add_u32 s3, s3, 0x120000
    v_mul_u32_u24 v60, 4224, v1
    s_lshl_b32 s61, s61, 10
    s_lshl_b32 s60, s33, 1
    s_add_u32 s60, s60, s61
    s_mov_b32 s50, 0x00010001
    s_mov_b32 s51, 0x00010001
    s_mov_b32 s7, 2000000
L_lw_47:
    ds_read_b32 v4, v2 offset:8
    s_waitcnt lgkmcnt(0)
    v_readfirstlane_b32 s6, v4
    s_cmp_ge_u32 s6, 50
    s_cbranch_scc1 L_ld_48
    s_sleep 1
    s_sub_u32 s7, s7, 1
    s_cmp_lg_u32 s7, 0
    s_cbranch_scc1 L_lw_47
L_ld_48:
    buffer_load_dwordx4 v[24:27], v78, s[52:55], s62 offen sc1
    buffer_load_dwordx4 v[28:31], v78, s[52:55], s32 offen sc1
    s_mov_b32 s7, 400000
    s_waitcnt vmcnt(0)
    v_cmpx_eq_u32 vcc, s36, v27
    v_cmpx_eq_u32 vcc, s36, v31
    s_nop 1
    s_cmp_eq_u64 exec, -1
    s_mov_b64 exec, -1
    s_cbranch_scc1 L_md_50
L_mp_49:
    s_cmp_gt_u32 s7, 399936
    s_cbranch_scc1 L_mn_51
    s_xor_b32 s62, s62, 0x400000
    s_xor_b32 s32, s32, 0x400000
L_mn_51:
    s_mov_b32 s6, 0
    v_cmp_ne_u32 vcc, s36, v27
    s_nop 0
    s_mov_b64 exec, vcc
    s_cbranch_execz L_ms_52
    buffer_load_dwordx4 v[24:27], v78, s[52:55], s62 offen sc1
    s_mov_b32 s6, 1
L_ms_52:
    s_mov_b64 exec, -1
    v_cmp_ne_u32 vcc, s36, v31
    s_nop 0
    s_mov_b64 exec, vcc
    s_cbranch_execz L_ms_53
    buffer_load_dwordx4 v[28:31], v78, s[52:55], s32 offen sc1
    s_mov_b32 s6, 1
L_ms_53:
    s_mov_b64 exec, -1
    s_cmp_eq_u32 s6, 0
    s_cbranch_scc1 L_md_50
    s_waitcnt vmcnt(0)
    s_sub_u32 s7, s7, 1
    s_cmp_lg_u32 s7, 0
    s_cbranch_scc1 L_mp_49
L_md_50:
    v_lshlrev_b32 v32, 8, v24
    v_perm_b32 v33, v25, v24, s47
    v_perm_b32 v34, v26, v25, s48
    v_and_b32 v35, 0xffffff00, v26
    v_lshlrev_b32 v36, 8, v28
    v_perm_b32 v37, v29, v28, s47
    v_perm_b32 v38, v30, v29, s48
    v_and_b32 v39, 0xffffff00, v30
    v_add_f32 v32, v32, v36
    v_add_f32 v33, v33, v37
    v_add_f32 v34, v34, v38
    v_add_f32 v35, v35, v39
    s_nop 0
    v_permlane32_swap_b32 v32, v34
    v_permlane32_swap_b32 v33, v35
    v_add_f32 v32, v32, v34
    v_add_f32 v33, v33, v35
    s_nop 1
    v_permlane16_swap_b32 v32, v33
    v_add_f32 v32, v32, v33
    s_mov_b32 s4, 0x3d372713
    v_cvt_pk_bf16_f32 v24, v32, v32
    v_and_b32 v24, 0xffff0000, v24
    v_add_f32 v24, v24, v62
    v_cvt_pk_bf16_f32 v24, v24, v24
    v_and_b32 v24, 0xffff0000, v24
    v_mul_f32 v25, v24, v24
    v_fma_f32 v25, v25, s4, 1.0
    v_mul_f32 v25, v25, v24
    v_mul_f32 v25, 0xc0135761, v25
    v_exp_f32 v25, v25
    s_nop 0
    v_add_f32 v25, 1.0, v25
    v_rcp_f32 v25, v25
    s_nop 0
    v_mul_f32 v25, v25, v24
    v_cvt_pk_bf16_f32 v25, v25, v25
    v_cndmask_b32 v25, 0, v25, s[42:43]
    ds_write_b16 v79, v25 offset:384
    s_mov_b64 exec, 1
    ds_add_u32 v2, v3 offset:28
    s_mov_b64 exec, -1
    s_mov_b32 s7, 2000000
L_lw_54:
    ds_read_b32 v4, v2 offset:32
    s_waitcnt lgkmcnt(0)
    v_readfirstlane_b32 s6, v4
    s_cmp_ge_u32 s6, 4
    s_cbranch_scc1 L_ld_55
    s_sleep 1
    s_sub_u32 s7, s7, 1
    s_cmp_lg_u32 s7, 0
    s_cbranch_scc1 L_lw_54
L_ld_55:
    s_mov_b32 s7, 400000
    buffer_load_dwordx4 v[84:87], v60, s[52:55], s3 offen sc1
    buffer_load_dwordx4 v[88:91], v60, s[52:55], s3 offen sc1
L_cpoll:
    buffer_load_dwordx4 v[92:95], v60, s[52:55], s3 offen sc1
    s_waitcnt vmcnt(2)
    v_cmpx_eq_u32 vcc, s36, v87
    s_nop 1
    s_cmp_eq_u64 exec, -1
    s_mov_b64 exec, -1
    s_cbranch_scc1 L_cgot0
    buffer_load_dwordx4 v[84:87], v60, s[52:55], s3 offen sc1
    s_waitcnt vmcnt(2)
    v_cmpx_eq_u32 vcc, s36, v91
    s_nop 1
    s_cmp_eq_u64 exec, -1
    s_mov_b64 exec, -1
    s_cbranch_scc1 L_cgot1
    buffer_load_dwordx4 v[88:91], v60, s[52:55], s3 offen sc1
    s_waitcnt vmcnt(2)
    v_cmpx_eq_u32 vcc, s36, v95
    s_nop 1
    s_cmp_eq_u64 exec, -1
    s_mov_b64 exec, -1
    s_cbranch_scc1 L_cgot2
    s_sub_u32 s7, s7, 1
    s_cmp_lg_u32 s7, 0
    s_cbranch_scc1 L_cpoll
L_cgot0:
    v_lshlrev_b32 v32, 8, v84
    v_perm_b32 v33, v85, v84, s47
    v_perm_b32 v34, v86, v85, s48
    v_and_b32 v35, 0xffffff00, v86
    s_branch L_cdone
L_cgot1:
    v_lshlrev_b32 v32, 8, v88
    v_perm_b32 v33, v89, v88, s47
    v_perm_b32 v34, v90, v89, s48
    v_and_b32 v35, 0xffffff00, v90
    s_branch L_cdone
L_cgot2:
    v_lshlrev_b32 v32, 8, v92
    v_perm_b32 v33, v93, v92, s47
    v_perm_b32 v34, v94, v93, s48
    v_and_b32 v35, 0xffffff00, v94
L_cdone:
    s_nop 0
    v_permlane32_swap_b32 v32, v34
    v_permlane32_swap_b32 v33, v35
    v_add_f32 v32, v32, v34
    v_add_f32 v33, v33, v35
    s_nop 1
    v_permlane16_swap_b32 v32, v33
    v_add_f32 v32, v32, v33
    s_nop 1
    v_add_f32_dpp v32, v32, v32 quad_perm:[1,0,3,2] row_mask:0xf bank_mask:0xf
    s_nop 1
    v_add_f32_dpp v32, v32, v32 quad_perm:[2,3,0,1] row_mask:0xf bank_mask:0xf
    s_nop 1
    v_add_f32_dpp v32, v32, v32 row_half_mirror row_mask:0xf bank_mask:0xf
    s_nop 1
    v_add_f32_dpp v32, v32, v32 row_mirror row_mask:0xf bank_mask:0xf
    v_add_f32 v32, v32, v82
    v_cvt_pk_bf16_f32 v32, v32, v32
    s_mov_b64 exec, s[50:51]
    buffer_store_short v32, v19, s[56:59], s60 offen
    s_cmp_lg_u32 s2, 0
    s_cbranch_scc1 L_noep
    s_mov_b64 exec, 1
    v_mov_b32 v26, s36
    buffer_store_dword v26, v2, s[52:55], 0 offen sc1
L_noep:
    s_mov_b64 exec, -1
L_end:
    s_endpgm
.section .rodata,"a"
.p2align 6
.amdhsa_kernel gated_mix__sliding_block_cached__dense_activation_gelu__decode_kernel
  .amdhsa_next_free_vgpr 160
  .amdhsa_next_free_sgpr 102
  .amdhsa_accum_offset 160
  .amdhsa_group_segment_fixed_size 0
  .amdhsa_kernarg_size 112
  .amdhsa_user_sgpr_count 2
  .amdhsa_user_sgpr_kernarg_segment_ptr 1
  .amdhsa_system_sgpr_workgroup_id_x 1
.end_amdhsa_kernel
```
